```python
import torch

def _softmax(x, axis=-1):
    return torch.softmax(x, dim=axis)
def _gelu(x):
    return torch.nn.functional.gelu(x, approximate="tanh")
def _silu(x):
    return torch.nn.functional.silu(x)
def _sigmoid(x):
    return torch.sigmoid(x)
def _layernorm(x, axis=-1, eps=1e-5):
    m = x.mean(dim=axis, keepdim=True)
    v = x.var(dim=axis, keepdim=True, unbiased=False)
    return (x - m) / torch.sqrt(v + eps)
def _scatter_add(tgt, idx, src, axis=0):
    return tgt.clone().index_add_(axis, idx, src)
def _segment_sum(src, seg, n):
    out = torch.zeros((n,) + src.shape[1:], dtype=src.dtype)
    return out.index_add_(0, seg, src)
def _pad(x, pw):
    flat = tuple(v for pair in reversed(pw) for v in pair)
    return torch.nn.functional.pad(x, flat)

kernel_name = 'gather_scatter__kernel_systems_refs_featgraph__graph'

def setup_inputs():

    _w = (lambda a: (lambda t: t.to(torch.bfloat16) if t.is_floating_point() else t)(torch.as_tensor(a)))
    N, deg, D = 12500, 64, 64
    E = N * deg
    scale = D ** -0.5
    src = (lambda lo, hi, *s: torch.randint(lo, hi, s))(0, N, E).to(torch.int64)
    dst = (lambda lo, hi, *s: torch.randint(lo, hi, s))(0, N, E).to(torch.int64)
    return {
        "x": _w((lambda *s: torch.randn(*s, dtype=torch.bfloat16) * 0.8)(N, D)),
        "src": _w(src),
        "dst": _w(dst),
        "w_q": _w((lambda *s: torch.randn(*s, dtype=torch.bfloat16) * 0.8)(D, D) * scale),
        "w_v": _w((lambda *s: torch.randn(*s, dtype=torch.bfloat16) * 0.05)(D, D) * scale),
    }

def reference(x, src, dst, w_q, w_v):
    N, D = x.shape
    xs = x[src]
    xd = x[dst]
    q = xd @ w_q
    logits = torch.einsum('ed,ed->e', xs, q) * (float(D) ** -0.5)
    alpha = _sigmoid(logits)
    msg = alpha[:, None] * (xs @ w_v)
    return _segment_sum(msg, dst, N)
```

```asm
; @launch grid=(256,1,1) block=(1024,1,1) lds=143152
.amdgcn_target "amdgcn-amd-amdhsa--gfx950"
.text
    .globl gather_scatter__kernel_systems_refs_featgraph__graph_kernel
    .p2align 8
    .type gather_scatter__kernel_systems_refs_featgraph__graph_kernel,@function
gather_scatter__kernel_systems_refs_featgraph__graph_kernel:
    s_load_dwordx8 s[4:11], s[0:1], 0
    s_load_dwordx8 s[48:55], s[0:1], 32
    s_cmp_ge_u32 s2, 256
    s_cbranch_scc1 K_end
    s_memrealtime s[56:57]
    v_lshrrev_b32 v1, 6, v0
    v_lshlrev_b32 v56, 4, v0
    v_readfirstlane_b32 s16, v1
    s_mul_i32 s18, s2, 12544
    v_add_u32 v57, s18, v56
    s_sub_u32 s18, 3200000, s18
    s_min_u32 s18, s18, 12544
    v_cmp_gt_u32 s[44:45], s18, v56
    s_andn2_b32 s17, 7, s2
    s_lshl_b32 s17, s17, 5
    s_lshr_b32 s19, s2, 3
    s_or_b32 s17, s17, s19
    v_mov_b32 v40, 3
    v_mov_b32 v48, 0xfc
    v_mov_b32 v41, 3
    v_mov_b32 v49, 0xfc
    v_mov_b32 v42, 3
    v_mov_b32 v50, 0xfc
    v_mov_b32 v43, 3
    v_mov_b32 v51, 0xfc
    v_add_u32 v61, 127536, v56
    v_mov_b32 v63, 0
    v_mov_b32 v55, 1
    s_waitcnt lgkmcnt(0)
    s_mov_b64 exec, s[44:45]
    s_cbranch_execz K_noload
    global_load_dwordx4 v[8:11], v57, s[8:9]
K_noload:
    s_mov_b64 exec, -1
    s_cmp_lg_u32 s16, 0
    s_cbranch_scc1 K_nz
    ds_write_b128 v56, v[40:43] offset:0
K_nz:
    v_cmp_gt_u32 vcc, 15616, v56
    s_and_saveexec_b64 s[20:21], vcc
    ds_write_b128 v61, v[48:51]
    s_mov_b64 exec, s[20:21]
    s_mov_b64 exec, s[44:45]
    s_cbranch_execz K_noload2
    global_load_dwordx4 v[12:15], v57, s[6:7]
K_noload2:
    s_mov_b64 exec, -1
    s_mov_b32 s12, s4
    s_and_b32 s13, s5, 0xffff
    s_mov_b32 s14, 1600000
    s_mov_b32 s15, 0x20000
    s_lshl_b32 s19, s16, 10
    s_add_u32 s19, s19, 19744
    s_mov_b32 m0, s19
    v_and_b32 v62, 0x1fff, v56
    s_cmp_ge_u32 s16, 8
    s_cselect_b32 s24, s48, s10
    s_cselect_b32 s25, s49, s11
    s_and_b32 s25, s25, 0xffff
    s_mov_b32 s26, 8192
    s_mov_b32 s27, 0x20000
    buffer_load_dwordx4 v62, s[24:27], 0 offen lds
    v_mov_b32 v2, v57
    v_lshrrev_b32 v53, 2, v0
    s_mul_i32 s18, s2, 15616
    v_add_u32 v57, s18, v56
    v_and_b32 v52, 0x3ff, v56
    s_lshl_b32 s19, s2, 11
    s_add_u32 s19, s19, 0x400000
    v_add_u32 v58, s19, v52
    s_cmp_lt_u32 s16, 12
    s_cbranch_scc1 K_nox
    v_and_b32 v59, 15, v0
    v_bfe_u32 v60, v0, 4, 2
    v_bfe_u32 v62, v0, 6, 2
    v_lshl_add_u32 v59, v62, 4, v59
    v_lshlrev_b32 v62, 15, v59
    v_lshl_add_u32 v62, v60, 4, v62
    s_lshl_b32 s19, s17, 7
    v_add_u32 v62, s19, v62
    buffer_load_dwordx4 v[96:99], v62, s[12:15], 0 offen
    buffer_load_dwordx4 v[100:103], v62, s[12:15], 0 offen offset:64
    s_cmp_lg_u32 s16, 14
    s_cbranch_scc1 K_nox
    s_mul_i32 s19, s2, 6272
    v_lshlrev_b32 v107, 3, v52
    v_add_u32 v107, s19, v107
    s_mov_b32 exec_hi, 0x1ffff
    buffer_load_dword v24, v107, s[12:15], 0 offen
    s_mov_b64 exec, -1
K_nox:
    s_waitcnt lgkmcnt(0)
    s_barrier
    s_cmp_lt_u32 s16, 12
    s_cbranch_scc1 K_eA
    s_cmp_eq_u32 s16, 12
    s_cbranch_scc0 K_b2
K_eB:
    s_waitcnt vmcnt(4)
    s_branch K_eC
K_eA:
    s_waitcnt vmcnt(2)
K_eC:
    s_mov_b64 exec, s[44:45]
    v_lshlrev_b32_sdwa v16, 2, v8 dst_sel:DWORD dst_unused:UNUSED_PAD src0_sel:DWORD src1_sel:BYTE_0
    ds_add_rtn_u32 v20, v16, v55 offset:0
    v_lshlrev_b32_sdwa v17, 2, v9 dst_sel:DWORD dst_unused:UNUSED_PAD src0_sel:DWORD src1_sel:BYTE_0
    ds_add_rtn_u32 v21, v17, v55 offset:0
    v_lshlrev_b32_sdwa v18, 2, v10 dst_sel:DWORD dst_unused:UNUSED_PAD src0_sel:DWORD src1_sel:BYTE_0
    ds_add_rtn_u32 v22, v18, v55 offset:0
    v_lshlrev_b32_sdwa v19, 2, v11 dst_sel:DWORD dst_unused:UNUSED_PAD src0_sel:DWORD src1_sel:BYTE_0
    ds_add_rtn_u32 v23, v19, v55 offset:0
    v_lshlrev_b32_sdwa v8, 2, v8 dst_sel:DWORD dst_unused:UNUSED_PAD src0_sel:DWORD src1_sel:BYTE_1
    v_lshlrev_b32_sdwa v9, 2, v9 dst_sel:DWORD dst_unused:UNUSED_PAD src0_sel:DWORD src1_sel:BYTE_1
    v_lshlrev_b32_sdwa v10, 2, v10 dst_sel:DWORD dst_unused:UNUSED_PAD src0_sel:DWORD src1_sel:BYTE_1
    v_lshlrev_b32_sdwa v11, 2, v11 dst_sel:DWORD dst_unused:UNUSED_PAD src0_sel:DWORD src1_sel:BYTE_1
    s_mov_b64 exec, -1
K_b2:
    s_waitcnt lgkmcnt(0)
    s_barrier
    s_cmp_eq_u32 s16, 13
    s_cbranch_scc1 K_scanB
    s_cmp_lg_u32 s16, 15
    s_cbranch_scc1 K_noscan
    ds_read_b128 v[40:43], v52 offset:0
    s_memrealtime s[60:61]
    s_waitcnt lgkmcnt(0)
    v_lshrrev_b32 v40, 2, v40
    v_lshrrev_b32 v41, 2, v41
    v_lshrrev_b32 v42, 2, v42
    v_lshrrev_b32 v43, 2, v43
    v_add3_u32 v44, v40, v41, v42
    s_add_u32 s60, s60, 350
    v_add_u32 v44, v44, v43
    s_addc_u32 s61, s61, 0
    s_lshl_b32 s92, s60, 22
    s_lshr_b32 s93, s60, 10
    v_add_u32_dpp v44, v44, v44 row_shr:1 row_mask:0xf bank_mask:0xf bound_ctrl:0
    s_lshl_b32 s93, s93, 22
    s_lshr_b32 s94, s60, 20
    v_add_u32_dpp v44, v44, v44 row_shr:2 row_mask:0xf bank_mask:0xf bound_ctrl:0
    s_lshl_b32 s94, s94, 22
    s_lshr_b64 s[96:97], s[60:61], 30
    v_add_u32_dpp v44, v44, v44 row_shr:4 row_mask:0xf bank_mask:0xf bound_ctrl:0
    s_lshl_b32 s95, s96, 22
    v_mov_b32 v16, s92
    v_add_u32_dpp v44, v44, v44 row_shr:8 row_mask:0xf bank_mask:0xf bound_ctrl:0
    v_mov_b32 v17, s93
    v_mov_b32 v18, s94
    v_add_u32_dpp v44, v44, v44 row_bcast:15 row_mask:0xa bank_mask:0xf
    v_mov_b32 v19, s95
    s_lshl_b32 s59, s61, 20
    v_add_u32_dpp v44, v44, v44 row_bcast:31 row_mask:0xc bank_mask:0xf
    ds_write_b128 v63, v[16:19] offset:1280
    v_mov_b32 v49, s60
    v_mov_b32 v51, s60
    ds_write_b32 v63, v49 offset:1300
    s_waitcnt lgkmcnt(0)
    s_barrier
    v_sub_u32 v47, v44, v43
    v_sub_u32 v46, v47, v42
    v_sub_u32 v45, v46, v41
    v_sub_u32 v44, v45, v40
    v_lshl_or_b32 v40, v40, 10, v44
    v_lshl_or_b32 v41, v41, 10, v45
    v_lshl_or_b32 v42, v42, 10, v46
    v_lshl_or_b32 v43, v43, 10, v47
    v_or_b32 v44, s59, v40
    v_mov_b32 v45, s60
    v_or_b32 v46, s59, v41
    v_mov_b32 v47, s60
    v_or_b32 v48, s59, v42
    v_or_b32 v50, s59, v43
    global_store_dwordx4 v58, v[44:47], s[54:55] sc1
    global_store_dwordx4 v58, v[48:51], s[54:55] offset:1024 sc1
    s_branch K_b3done
K_scanB:
    ds_read_b128 v[40:43], v52 offset:0
    s_mov_b32 s58, 127524
    s_waitcnt lgkmcnt(0)
    v_lshrrev_b32 v40, 2, v40
    v_lshrrev_b32 v41, 2, v41
    v_lshrrev_b32 v42, 2, v42
    v_lshrrev_b32 v43, 2, v43
    v_add3_u32 v44, v40, v41, v42
    v_add_u32 v44, v44, v43
    v_lshlrev_b32 v51, 4, v43
    v_lshlrev_b32 v50, 4, v42
    v_add_u32_dpp v44, v44, v44 row_shr:1 row_mask:0xf bank_mask:0xf bound_ctrl:0
    v_sub_u32 v51, s58, v51
    v_lshlrev_b32 v49, 4, v41
    v_add_u32_dpp v44, v44, v44 row_shr:2 row_mask:0xf bank_mask:0xf bound_ctrl:0
    v_sub_u32 v50, v51, v50
    v_lshlrev_b32 v48, 4, v40
    v_add_u32_dpp v44, v44, v44 row_shr:4 row_mask:0xf bank_mask:0xf bound_ctrl:0
    v_sub_u32 v49, v50, v49
    v_sub_u32 v48, v49, v48
    v_add_u32_dpp v44, v44, v44 row_shr:8 row_mask:0xf bank_mask:0xf bound_ctrl:0
    s_nop 0
    s_nop 0
    v_add_u32_dpp v44, v44, v44 row_bcast:15 row_mask:0xa bank_mask:0xf
    s_nop 0
    s_nop 0
    v_add_u32_dpp v44, v44, v44 row_bcast:31 row_mask:0xc bank_mask:0xf
    v_lshl_add_u32 v48, v44, 4, v48
    v_lshl_add_u32 v49, v44, 4, v49
    v_lshl_add_u32 v50, v44, 4, v50
    v_lshl_add_u32 v51, v44, 4, v51
    ds_write_b128 v52, v[48:51] offset:1312
    s_mov_b32 exec_lo, 0
    s_mov_b32 exec_hi, 0x80000000
    ds_write_b32 v63, v44 offset:1296
    s_mov_b64 exec, -1
K_noscan:
    s_waitcnt lgkmcnt(0)
    s_barrier
K_b3done:
    s_mov_b64 exec, s[44:45]
    ds_read_b32 v16, v16 offset:1312
    ds_read_b32 v17, v17 offset:1312
    ds_read_b32 v18, v18 offset:1312
    ds_read_b32 v19, v19 offset:1312
    s_mov_b64 exec, -1
    ds_read_b64 v[54:55], v63 offset:1296
    s_lshr_b32 s18, s17, 2
    s_lshl_b32 s18, s18, 4
    s_and_b32 s19, s17, 1
    s_lshl_b32 s19, s19, 3
    s_or_b32 s18, s18, s19
    s_and_b32 s19, s17, 2
    s_lshl_b32 s19, s19, 9
    s_or_b32 s18, s18, s19
    s_add_u32 s18, s18, 0x400000
    v_lshl_add_u32 v58, v53, 11, s18
    s_cmp_eq_u32 s16, 15
    s_cbranch_scc1 K_w14
    s_waitcnt vmcnt(0)
K_w14:
    s_mov_b64 exec, s[44:45]
    v_lshl_or_b32 v12, v12, 8, v8
    v_lshl_or_b32 v13, v13, 8, v9
    v_lshl_or_b32 v14, v14, 8, v10
    v_lshl_or_b32 v15, v15, 8, v11
    s_waitcnt lgkmcnt(4)
    v_lshl_add_u32 v16, v20, 2, v16
    ds_write_b32 v16, v12
    s_waitcnt lgkmcnt(4)
    v_lshl_add_u32 v17, v21, 2, v17
    ds_write_b32 v17, v13
    s_waitcnt lgkmcnt(4)
    v_lshl_add_u32 v18, v22, 2, v18
    ds_write_b32 v18, v14
    s_waitcnt lgkmcnt(4)
    v_lshl_add_u32 v19, v23, 2, v19
    ds_write_b32 v19, v15
    s_mov_b64 exec, -1
    s_waitcnt lgkmcnt(0)
    s_barrier
    ds_read_b128 v[40:43], v61
    ds_read_b128 v[16:19], v63 offset:1280
    v_cmp_gt_u32 vcc, v54, v0
    s_and_saveexec_b64 s[20:21], vcc
    s_mov_b32 s58, 0
    s_cbranch_execz K_nost
    s_mov_b32 s58, 1
    s_waitcnt lgkmcnt(0)
    v_or_b32 v40, v16, v40
    v_or_b32 v41, v17, v41
    v_or_b32 v42, v18, v42
    v_or_b32 v43, v19, v43
    global_store_dwordx4 v57, v[40:43], s[54:55] sc1
K_nost:
    s_mov_b64 exec, -1
    v_readfirstlane_b32 s62, v55
    v_mov_b32 v44, 0x7fffff80
    v_mov_b32 v48, 0
    v_mov_b32 v45, 0x7fffff80
    v_mov_b32 v49, 0
    v_mov_b32 v46, 0x7fffff80
    v_mov_b32 v50, 0
    v_mov_b32 v47, 0x7fffff80
    v_mov_b32 v51, 0
    ds_write_b128 v56, v[44:47] offset:36128
    v_cmp_gt_u32 vcc, 9488, v56
    s_and_saveexec_b64 s[20:21], vcc
    ds_write_b128 v56, v[44:47] offset:52512
    s_mov_b64 exec, s[20:21]
    v_cmp_gt_u32 vcc, 256, v56
    s_and_saveexec_b64 s[20:21], vcc
    ds_write_b128 v56, v[48:51] offset:1024
    ds_write_b32 v63, v63 offset:1304
    s_mov_b64 exec, s[20:21]
    v_and_b32 v52, 3, v0
    v_lshlrev_b32 v1, 4, v52
    s_mov_b32 s22, 0xaaaaaaaa
    s_mov_b32 s23, 0xaaaaaaaa
    s_mov_b32 s28, 0xcccccccc
    s_mov_b32 s29, 0xcccccccc
    v_mov_b32 v3, 0xffff
    v_mov_b32 v4, 0xffff0000
    v_cndmask_b32 v4, v3, v4, s[22:23]
    v_cndmask_b32 v3, v4, v63, s[28:29]
    v_cndmask_b32 v4, v63, v4, s[28:29]
    s_mov_b32 s30, 0xbe38aa3b
    s_mov_b32 s31, 15616
    v_mul_u32_u24 v62, s31, v53
    v_add_u32 v62, v62, v1
    s_mov_b32 s33, 0
    s_mov_b32 s37, 0
    s_mov_b32 s31, 132
    s_movk_i32 s43, 252
    v_lshrrev_b32 v7, 4, v0
    v_min_u32 v6, 48, v7
    v_mul_u32_u24 v5, 528, v6
    v_bfe_u32 v54, v0, 2, 2
    v_lshl_add_u32 v5, v54, 2, v5
    v_sub_u32 v54, v7, v6
    v_lshl_add_u32 v5, v54, 6, v5
    v_add_u32 v5, 36128, v5
    v_lshlrev_b32 v6, 1, v6
    v_sub_u32 v6, v1, v6
    v_mov_b32 v24, 0
    v_mov_b32 v25, 0
    v_mov_b32 v26, 0
    v_mov_b32 v27, 0
    v_mov_b32 v28, 0
    v_mov_b32 v29, 0
    v_mov_b32 v30, 0
    v_mov_b32 v31, 0
    v_mov_b32 v32, 0
    v_mov_b32 v33, 0
    v_mov_b32 v34, 0
    v_mov_b32 v35, 0
    v_mov_b32 v36, 0
    v_mov_b32 v37, 0
    v_mov_b32 v38, 0
    v_mov_b32 v39, 0
    s_cmp_lg_u32 s16, 15
    s_cbranch_scc1 K_w15
    s_waitcnt vmcnt(0)
K_w15:
    s_waitcnt lgkmcnt(0)
    s_barrier
    global_load_dwordx2 v[8:9], v58, s[54:55] sc1
    s_mov_b32 s58, 0
    s_cmp_lt_u32 s16, 12
    s_cbranch_scc1 K_noq
    v_bfe_u32 v16, v0, 2, 2
    v_lshl_add_u32 v16, v60, 3, v16
    v_lshlrev_b32 v16, 7, v16
    v_lshl_add_u32 v16, v1, 1, v16
    ds_read_b64_tr_b16 v[64:65], v16 offset:19744
    ds_read_b64_tr_b16 v[66:67], v16 offset:20256
    ds_read_b64_tr_b16 v[72:73], v16 offset:19752
    ds_read_b64_tr_b16 v[74:75], v16 offset:20264
    ds_read_b64_tr_b16 v[80:81], v16 offset:19760
    ds_read_b64_tr_b16 v[82:83], v16 offset:20272
    ds_read_b64_tr_b16 v[88:89], v16 offset:19768
    ds_read_b64_tr_b16 v[90:91], v16 offset:20280
    ds_read_b64_tr_b16 v[68:69], v16 offset:23840
    ds_read_b64_tr_b16 v[70:71], v16 offset:24352
    ds_read_b64_tr_b16 v[76:77], v16 offset:23848
    ds_read_b64_tr_b16 v[78:79], v16 offset:24360
    ds_read_b64_tr_b16 v[84:85], v16 offset:23856
    ds_read_b64_tr_b16 v[86:87], v16 offset:24368
    ds_read_b64_tr_b16 v[92:93], v16 offset:23864
    ds_read_b64_tr_b16 v[94:95], v16 offset:24376
    v_mul_u32_u24 v17, 144, v59
    v_lshl_add_u32 v17, v60, 5, v17
    s_waitcnt lgkmcnt(8)
    v_mfma_f32_16x16x32_bf16 v[104:107], v[64:67], v[96:99], 0
    v_mfma_f32_16x16x32_bf16 v[108:111], v[72:75], v[96:99], 0
    v_mfma_f32_16x16x32_bf16 v[112:115], v[80:83], v[96:99], 0
    v_mfma_f32_16x16x32_bf16 v[116:119], v[88:91], v[96:99], 0
    s_waitcnt lgkmcnt(0)
    v_mfma_f32_16x16x32_bf16 v[104:107], v[68:71], v[100:103], v[104:107]
    v_mfma_f32_16x16x32_bf16 v[108:111], v[76:79], v[100:103], v[108:111]
    v_mfma_f32_16x16x32_bf16 v[112:115], v[84:87], v[100:103], v[112:115]
    v_mfma_f32_16x16x32_bf16 v[116:119], v[92:95], v[100:103], v[116:119]
    s_nop 7
    v_cvt_pk_bf16_f32 v64, v104, v105
    v_cvt_pk_bf16_f32 v65, v106, v107
    v_cvt_pk_bf16_f32 v66, v108, v109
    v_cvt_pk_bf16_f32 v67, v110, v111
    v_cvt_pk_bf16_f32 v68, v112, v113
    v_cvt_pk_bf16_f32 v69, v114, v115
    v_cvt_pk_bf16_f32 v70, v116, v117
    v_cvt_pk_bf16_f32 v71, v118, v119
    ds_write_b128 v17, v[64:67] offset:10528
    ds_write_b128 v17, v[68:71] offset:10544
K_noq:
    v_mov_b32 v96, 0
    v_mov_b32 v97, 0
    v_mov_b32 v98, 0
    v_mov_b32 v99, 0
    v_mov_b32 v100, 0
    v_mov_b32 v101, 0
    v_mov_b32 v102, 0
    v_mov_b32 v103, 0
    v_mov_b32 v104, 0
    v_mov_b32 v105, 0
    v_mov_b32 v106, 0
    v_mov_b32 v107, 0
    v_mov_b32 v108, 0
    v_mov_b32 v109, 0
    v_mov_b32 v110, 0
    v_mov_b32 v111, 0
    v_mov_b32 v112, 0
    v_mov_b32 v113, 0
    v_mov_b32 v114, 0
    v_mov_b32 v115, 0
    v_mov_b32 v116, 0
    v_mov_b32 v117, 0
    v_mov_b32 v118, 0
    v_mov_b32 v119, 0
    v_mov_b32 v120, 0
    v_mov_b32 v121, 0
    v_mov_b32 v122, 0
    v_mov_b32 v123, 0
    v_mov_b32 v124, 0
    v_mov_b32 v125, 0
    v_mov_b32 v126, 0
    v_mov_b32 v127, 0
    s_memrealtime s[60:61]
    s_cmp_eq_u32 s58, 0
    s_mov_b32 s58, 0
    s_cbranch_scc1 K_tp
    s_waitcnt vmcnt(1) lgkmcnt(0)
    s_branch K_tp1
K_tp:
    s_waitcnt vmcnt(0) lgkmcnt(0)
K_tp1:
    s_add_u32 s60, s60, 550
    s_addc_u32 s61, s61, 0
    s_sub_u32 s60, s60, s56
    s_and_b32 s61, s61, 0xfff
    s_and_b32 s59, s57, 0xfff
    v_mov_b32 v2, v8
    v_mov_b32 v61, v9
    v_subrev_u32 v9, s56, v9
    v_lshrrev_b32 v8, 20, v8
    v_cmp_ne_u32 s[20:21], s61, v8
    v_cmp_ne_u32 s[44:45], s59, v8
    v_cmp_lt_u32 vcc, s60, v9
    s_and_b64 s[20:21], s[20:21], s[44:45]
    s_or_b64 exec, vcc, s[20:21]
    s_cbranch_execz K_tok
    global_load_dwordx2 v[8:9], v58, s[54:55] sc1
    s_memrealtime s[60:61]
    s_add_u32 s58, s58, 1
    s_cmp_lt_u32 s58, 6
    s_cbranch_scc1 K_tp
    global_load_dwordx2 v[10:11], v63, s[52:53] sc1
    s_cmp_ge_u32 s58, 200000
    s_cbranch_scc1 K_end
    s_waitcnt vmcnt(0)
    v_readfirstlane_b32 s20, v10
    v_readfirstlane_b32 s21, v11
    s_cmp_eq_u64 s[20:21], 0
    s_cbranch_scc1 K_tp
    s_not_b64 s[56:57], s[20:21]
    s_branch K_tp
K_tok:
    s_mov_b64 exec, -1
K_batch:
    v_and_b32 v56, 0x3ff, v2
    v_bfe_u32 v57, v2, 10, 10
    v_add_u32 v56, s33, v56
    v_lshl_add_u32 v56, v56, 4, v62
    v_subrev_u32 v57, s33, v57
    v_cmp_lt_i32 vcc, 8, v57
    v_sub_u32 v57, v57, v52
    v_cmp_lt_i32 s[44:45], 0, v57
    v_cmp_lt_i32 s[46:47], 4, v57
    v_mov_b32 v40, 0x7e
    v_mov_b32 v41, 0x7e
    v_mov_b32 v42, 0x7e
    v_mov_b32 v43, 0x7e
    v_mov_b32 v44, 0x7e
    v_mov_b32 v45, 0x7e
    v_mov_b32 v46, 0x7e
    v_mov_b32 v47, 0x7e
    s_mov_b64 exec, s[44:45]
    s_cbranch_execz K_e1a
    global_load_dwordx4 v[40:43], v56, s[54:55] sc1
K_e1a:
    s_mov_b64 exec, s[46:47]
    s_cbranch_execz K_e2a
    global_load_dwordx4 v[44:47], v56, s[54:55] offset:64 sc1
K_e2a:
    s_mov_b64 exec, -1
    v_lshlrev_b32 v20, 22, v61
    v_lshrrev_b32 v21, 10, v61
    v_lshrrev_b32 v22, 20, v61
    v_lshrrev_b32 v23, 20, v2
    v_lshlrev_b32 v21, 22, v21
    v_lshlrev_b32 v22, 22, v22
    v_alignbit_b32 v23, v23, v61, 30
    v_lshlrev_b32 v23, 22, v23
    s_mov_b64 exec, -1
    v_mov_b32 v58, 1
    s_mov_b32 s58, 0
    s_mov_b32 s18, 0x400000
    s_mov_b32 s19, 33264
    s_cbranch_vccz K_nf
    v_mov_b32 v16, 0x40000000
    ds_or_b32 v63, v16 offset:1276
K_nf:
    v_subrev_u32 v16, s62, v61
    v_cmp_lt_i32 vcc, 0x15e, v16
    s_cbranch_vccz K_ep
    s_mov_b64 exec, 1
    ds_or_rtn_b32 v16, v63, v58 offset:1304
    s_waitcnt lgkmcnt(0)
    v_cmpx_eq_u32 vcc, 0, v16
    s_cbranch_execz K_nrec
    s_not_b64 s[20:21], s[56:57]
    v_mov_b32 v16, s20
    v_mov_b32 v17, s21
    global_atomic_umax_x2 v63, v[16:17], s[52:53] sc1
K_nrec:
    s_mov_b64 exec, -1
K_ep:
    s_waitcnt vmcnt(0)
    s_mov_b64 exec, s[44:45]
    s_mov_b64 s[38:39], s[44:45]
    v_xor_b32 v40, v20, v40
    v_xor_b32 v41, v21, v41
    v_xor_b32 v42, v22, v42
    v_xor_b32 v43, v23, v43
    v_or3_b32 v16, v40, v41, v42
    v_or_b32 v16, v16, v43
    v_cmp_le_u32 s[44:45], s18, v16
    s_mov_b64 exec, s[46:47]
    s_mov_b64 s[40:41], s[46:47]
    v_xor_b32 v44, v20, v44
    v_xor_b32 v45, v21, v45
    v_xor_b32 v46, v22, v46
    v_xor_b32 v47, v23, v47
    v_or3_b32 v16, v44, v45, v46
    v_or_b32 v16, v16, v47
    v_cmp_le_u32 s[46:47], s18, v16
    s_andn2_b64 s[38:39], s[38:39], s[44:45]
    s_andn2_b64 s[40:41], s[40:41], s[46:47]
    s_or_b64 s[20:21], s[44:45], s[46:47]
    s_cbranch_scc0 K_nore
    s_mov_b64 exec, s[44:45]
    s_cbranch_execz K_e1b
    global_load_dwordx4 v[40:43], v56, s[54:55] sc1
K_e1b:
    s_mov_b64 exec, s[46:47]
    s_cbranch_execz K_e2b
    global_load_dwordx4 v[44:47], v56, s[54:55] offset:64 sc1
K_e2b:
K_nore:
    s_mov_b64 exec, s[38:39]
    v_and_b32 v48, 0xff, v40
    v_and_b32 v49, 0xff, v41
    v_and_b32 v50, 0xff, v42
    v_and_b32 v51, 0xff, v43
    v_cmpx_ne_u32 vcc, s43, v48
    ds_add_rtn_u32 v8, v48, v58 offset:1024
    v_cmpx_ne_u32 vcc, s43, v49
    ds_add_rtn_u32 v9, v49, v58 offset:1024
    v_cmpx_ne_u32 vcc, s43, v50
    ds_add_rtn_u32 v10, v50, v58 offset:1024
    v_cmpx_ne_u32 vcc, s43, v51
    ds_add_rtn_u32 v11, v51, v58 offset:1024
    s_mov_b64 exec, s[40:41]
    s_cbranch_execz K_at_done
    v_and_b32 v52, 0xff, v44
    v_and_b32 v53, 0xff, v45
    v_and_b32 v54, 0xff, v46
    v_and_b32 v55, 0xff, v47
    v_cmpx_ne_u32 vcc, s43, v52
    s_cbranch_execz K_at_done
    ds_add_rtn_u32 v12, v52, v58 offset:1024
    v_cmpx_ne_u32 vcc, s43, v53
    s_cbranch_execz K_at_done
    ds_add_rtn_u32 v13, v53, v58 offset:1024
    v_cmpx_ne_u32 vcc, s43, v54
    s_cbranch_execz K_at_done
    ds_add_rtn_u32 v14, v54, v58 offset:1024
    v_cmpx_ne_u32 vcc, s43, v55
    s_cbranch_execz K_at_done
    ds_add_rtn_u32 v15, v55, v58 offset:1024
K_at_done:
    s_mov_b64 exec, s[38:39]
    v_lshrrev_b32 v40, 1, v40
    v_mul_u32_u24 v48, s31, v48
    v_lshrrev_b32 v41, 1, v41
    v_mul_u32_u24 v49, s31, v49
    v_lshrrev_b32 v42, 1, v42
    v_mul_u32_u24 v50, s31, v50
    v_lshrrev_b32 v43, 1, v43
    v_mul_u32_u24 v51, s31, v51
    s_mov_b64 exec, s[40:41]
    v_lshrrev_b32 v44, 1, v44
    v_mul_u32_u24 v52, s31, v52
    v_lshrrev_b32 v45, 1, v45
    v_mul_u32_u24 v53, s31, v53
    v_lshrrev_b32 v46, 1, v46
    v_mul_u32_u24 v54, s31, v54
    v_lshrrev_b32 v47, 1, v47
    v_mul_u32_u24 v55, s31, v55
    s_waitcnt lgkmcnt(0)
    s_mov_b64 exec, s[38:39]
    v_cmpx_ne_u32 vcc, s19, v48
    v_lshl_add_u32 v48, v8, 2, v48
    ds_write_b32 v48, v40 offset:36128
    v_cmpx_ne_u32 vcc, s19, v49
    v_lshl_add_u32 v49, v9, 2, v49
    ds_write_b32 v49, v41 offset:36128
    v_cmpx_ne_u32 vcc, s19, v50
    v_lshl_add_u32 v50, v10, 2, v50
    ds_write_b32 v50, v42 offset:36128
    v_cmpx_ne_u32 vcc, s19, v51
    v_lshl_add_u32 v51, v11, 2, v51
    ds_write_b32 v51, v43 offset:36128
    s_mov_b64 exec, s[40:41]
    v_cmpx_ne_u32 vcc, s19, v52
    s_cbranch_execz K_sc_done
    v_lshl_add_u32 v52, v12, 2, v52
    ds_write_b32 v52, v44 offset:36128
    v_cmpx_ne_u32 vcc, s19, v53
    s_cbranch_execz K_sc_done
    v_lshl_add_u32 v53, v13, 2, v53
    ds_write_b32 v53, v45 offset:36128
    v_cmpx_ne_u32 vcc, s19, v54
    s_cbranch_execz K_sc_done
    v_lshl_add_u32 v54, v14, 2, v54
    ds_write_b32 v54, v46 offset:36128
    v_cmpx_ne_u32 vcc, s19, v55
    s_cbranch_execz K_sc_done
    v_lshl_add_u32 v55, v15, 2, v55
    ds_write_b32 v55, v47 offset:36128
K_sc_done:
    s_mov_b64 exec, -1
    s_cmp_eq_u64 s[20:21], 0
    s_cbranch_scc1 K_eok
    s_add_u32 s58, s58, 1
    s_cmp_lt_u32 s58, 200000
    s_cbranch_scc1 K_ep
    s_endpgm
K_eok:
    v_and_b32 v56, 63, v0
    v_lshlrev_b32 v56, 2, v56
    v_min_u32 v59, 48, v7
    v_mul_u32_u24 v60, 144, v59
    v_add_u32 v60, v60, v1
    v_lshlrev_b32 v59, 2, v59
    s_movk_i32 s41, 64
    s_cmp_eq_u32 s16, 12
    s_cselect_b32 s41, 256, s41
    s_movk_i32 s35, 128
    s_mov_b32 s38, 0
    s_mov_b32 s42, 0
    s_cmp_ge_u32 s16, 6
    s_cbranch_scc1 K_b5
    s_mov_b32 s18, 0x7fffff80
    s_movk_i32 s19, 16
K_try:
    ds_read2_b32 v[48:49], v5 offset0:0 offset1:4
    ds_read2_b32 v[50:51], v5 offset0:8 offset1:12
    s_waitcnt lgkmcnt(0)
    v_max3_u32 v53, v48, v49, v50
    v_max_u32 v53, v53, v51
    v_cmp_eq_u32 vcc, s18, v53
    s_cbranch_vccz K_early
    s_sub_u32 s19, s19, 1
    s_cmp_lg_u32 s19, 0
    s_cbranch_scc1 K_try
    s_branch K_b5
K_early:
    s_mov_b32 s42, 1
    v_add_u32 v48, v48, v6
    buffer_load_dwordx4 v[64:67], v48, s[12:15], 0 offen
    buffer_load_dwordx4 v[68:71], v48, s[12:15], 0 offen offset:64
    v_add_u32 v49, v49, v6
    buffer_load_dwordx4 v[72:75], v49, s[12:15], 0 offen
    buffer_load_dwordx4 v[76:79], v49, s[12:15], 0 offen offset:64
    v_add_u32 v50, v50, v6
    buffer_load_dwordx4 v[80:83], v50, s[12:15], 0 offen
    buffer_load_dwordx4 v[84:87], v50, s[12:15], 0 offen offset:64
    v_add_u32 v51, v51, v6
    buffer_load_dwordx4 v[88:91], v51, s[12:15], 0 offen
    buffer_load_dwordx4 v[92:95], v51, s[12:15], 0 offen offset:64
K_b5:
    s_waitcnt lgkmcnt(0)
    s_barrier
    ds_read2_b32 v[48:49], v5 offset0:0 offset1:4
    ds_read2_b32 v[50:51], v5 offset0:8 offset1:12
    ds_read_b32 v56, v56 offset:1024
    ds_read_b32 v59, v59 offset:1024
    ds_read_b128 v[16:19], v60 offset:10528
    ds_read_b128 v[20:23], v60 offset:10592
    s_cmp_gt_u32 s16, 12
    s_cbranch_scc1 K_now0
    s_cmp_lg_u32 s42, 0
    s_cbranch_scc1 K_now0
    s_waitcnt lgkmcnt(4)
    v_add_u32 v48, v48, v6
    buffer_load_dwordx4 v[64:67], v48, s[12:15], 0 offen
    buffer_load_dwordx4 v[68:71], v48, s[12:15], 0 offen offset:64
    v_add_u32 v49, v49, v6
    buffer_load_dwordx4 v[72:75], v49, s[12:15], 0 offen
    buffer_load_dwordx4 v[76:79], v49, s[12:15], 0 offen offset:64
    v_add_u32 v50, v50, v6
    buffer_load_dwordx4 v[80:83], v50, s[12:15], 0 offen
    buffer_load_dwordx4 v[84:87], v50, s[12:15], 0 offen offset:64
    v_add_u32 v51, v51, v6
    buffer_load_dwordx4 v[88:91], v51, s[12:15], 0 offen
    buffer_load_dwordx4 v[92:95], v51, s[12:15], 0 offen offset:64
K_now0:
    s_waitcnt lgkmcnt(2)
    v_readlane_b32 s34, v56, 63
    v_and_b32 v56, 0xffff, v56
    v_cmp_lt_u32 vcc, s35, v56
    s_cbranch_vccnz K_ovf
K_pass:
    s_cmp_gt_u32 s16, 12
    s_cbranch_scc1 K_rdone
    v_readlane_b32 s35, v59, 0
    v_readlane_b32 s36, v59, 16
    v_readlane_b32 s39, v59, 32
    v_readlane_b32 s40, v59, 48
    s_max_u32 s35, s35, s36
    s_max_u32 s39, s39, s40
    s_max_u32 s35, s35, s39
    s_sub_i32 s35, s35, s37
    s_max_i32 s35, s35, 0
    s_min_u32 s35, s35, 128
    s_cmp_lg_u32 s16, 12
    s_cbranch_scc1 K_norm
    s_and_b32 s36, s35, 63
    s_min_u32 s36, s36, 16
    s_lshr_b32 s35, s35, 6
    s_lshl_b32 s35, s35, 4
    s_add_u32 s35, s35, s36
K_norm:
    s_cmp_le_u32 s35, 16
    s_cbranch_scc1 K_last0
    s_sub_u32 s36, s35, 1
    s_bfe_u32 s39, s36, 0x20002
    s_lshr_b32 s36, s36, 4
    s_mul_i32 s40, s36, s41
    v_add_u32 v56, s40, v5
    v_add_u32 v57, s41, v5
    ds_read2_b32 v[8:9], v56 offset0:0 offset1:4
    ds_read2_b32 v[10:11], v56 offset0:8 offset1:12
    s_waitcnt lgkmcnt(0)
    v_add_u32 v8, v8, v6
    buffer_load_dwordx4 v[96:99], v8, s[12:15], 0 offen
    buffer_load_dwordx4 v[100:103], v8, s[12:15], 0 offen offset:64
    s_cmp_eq_u32 s39, 0
    s_cbranch_scc1 K_t0
    v_add_u32 v9, v9, v6
    buffer_load_dwordx4 v[104:107], v9, s[12:15], 0 offen
    buffer_load_dwordx4 v[108:111], v9, s[12:15], 0 offen offset:64
    s_cmp_eq_u32 s39, 1
    s_cbranch_scc1 K_t1
    v_add_u32 v10, v10, v6
    buffer_load_dwordx4 v[112:115], v10, s[12:15], 0 offen
    buffer_load_dwordx4 v[116:119], v10, s[12:15], 0 offen offset:64
    s_cmp_eq_u32 s39, 2
    s_cbranch_scc1 K_t2
    v_add_u32 v11, v11, v6
    buffer_load_dwordx4 v[120:123], v11, s[12:15], 0 offen
    buffer_load_dwordx4 v[124:127], v11, s[12:15], 0 offen offset:64
K_loop0:
    s_waitcnt vmcnt(8)
K_go0:
    s_cmp_lt_u32 s36, 2
    s_cbranch_scc1 K_pen0
    ds_read2_b32 v[8:9], v57 offset0:0 offset1:4
    ds_read2_b32 v[10:11], v57 offset0:8 offset1:12
    v_add_u32 v57, s41, v57
    s_sub_u32 s36, s36, 1
    .p2align 3
    v_mfma_f32_4x4x4_16b_bf16 v[40:43], v[64:65], v[16:17], 0
    v_mfma_f32_4x4x4_16b_bf16 v[44:47], v[72:73], v[16:17], 0
    v_mfma_f32_4x4x4_16b_bf16 v[48:51], v[80:81], v[16:17], 0
    v_mfma_f32_4x4x4_16b_bf16 v[52:55], v[88:89], v[16:17], 0
    v_mfma_f32_4x4x4_16b_bf16 v[40:43], v[66:67], v[18:19], v[40:43]
    v_mfma_f32_4x4x4_16b_bf16 v[44:47], v[74:75], v[18:19], v[44:47]
    v_mfma_f32_4x4x4_16b_bf16 v[48:51], v[82:83], v[18:19], v[48:51]
    v_mfma_f32_4x4x4_16b_bf16 v[52:55], v[90:91], v[18:19], v[52:55]
    v_mfma_f32_4x4x4_16b_bf16 v[40:43], v[68:69], v[20:21], v[40:43]
    v_mfma_f32_4x4x4_16b_bf16 v[44:47], v[76:77], v[20:21], v[44:47]
    v_mfma_f32_4x4x4_16b_bf16 v[48:51], v[84:85], v[20:21], v[48:51]
    v_mfma_f32_4x4x4_16b_bf16 v[52:55], v[92:93], v[20:21], v[52:55]
    v_mfma_f32_4x4x4_16b_bf16 v[40:43], v[70:71], v[22:23], v[40:43]
    v_mfma_f32_4x4x4_16b_bf16 v[44:47], v[78:79], v[22:23], v[44:47]
    v_mfma_f32_4x4x4_16b_bf16 v[48:51], v[86:87], v[22:23], v[48:51]
    v_mfma_f32_4x4x4_16b_bf16 v[52:55], v[94:95], v[22:23], v[52:55]
    s_waitcnt lgkmcnt(0)
    v_add_u32 v8, v8, v6
    v_add_f32_dpp v40, v41, v40 quad_perm:[1,1,1,1] row_mask:0xf bank_mask:0xf
    v_add_f32_dpp v45, v44, v45 quad_perm:[0,0,0,0] row_mask:0xf bank_mask:0xf
    v_add_f32_dpp v50, v48, v50 quad_perm:[0,0,0,0] row_mask:0xf bank_mask:0xf
    v_add_f32_dpp v55, v52, v55 quad_perm:[0,0,0,0] row_mask:0xf bank_mask:0xf
    v_add_f32_dpp v40, v42, v40 quad_perm:[2,2,2,2] row_mask:0xf bank_mask:0xf
    v_add_f32_dpp v45, v46, v45 quad_perm:[2,2,2,2] row_mask:0xf bank_mask:0xf
    v_add_f32_dpp v50, v49, v50 quad_perm:[1,1,1,1] row_mask:0xf bank_mask:0xf
    v_add_f32_dpp v55, v53, v55 quad_perm:[1,1,1,1] row_mask:0xf bank_mask:0xf
    v_add_f32_dpp v40, v43, v40 quad_perm:[3,3,3,3] row_mask:0xf bank_mask:0xf
    v_add_f32_dpp v45, v47, v45 quad_perm:[3,3,3,3] row_mask:0xf bank_mask:0xf
    v_add_f32_dpp v50, v51, v50 quad_perm:[3,3,3,3] row_mask:0xf bank_mask:0xf
    v_add_f32_dpp v55, v54, v55 quad_perm:[2,2,2,2] row_mask:0xf bank_mask:0xf
    v_cndmask_b32 v40, v40, v45, s[22:23]
    v_cndmask_b32 v50, v50, v55, s[22:23]
    v_cndmask_b32 v56, v40, v50, s[28:29]
    v_mul_f32 v56, s30, v56
    v_exp_f32 v56, v56
    v_add_u32 v9, v9, v6
    v_add_f32 v56, 1.0, v56
    v_rcp_f32 v56, v56
    v_add_u32 v10, v10, v6
    v_cvt_pk_bf16_f32 v56, v56, v56
    s_nop 0
    v_add_u32 v11, v11, v6
    v_and_b32_dpp v40, v56, v3 quad_perm:[0,0,0,0] row_mask:0xf bank_mask:0xf
    v_and_b32_dpp v41, v56, v4 quad_perm:[0,0,0,0] row_mask:0xf bank_mask:0xf
    v_and_b32_dpp v42, v56, v3 quad_perm:[1,1,1,1] row_mask:0xf bank_mask:0xf
    v_and_b32_dpp v43, v56, v4 quad_perm:[1,1,1,1] row_mask:0xf bank_mask:0xf
    v_and_b32_dpp v44, v56, v3 quad_perm:[2,2,2,2] row_mask:0xf bank_mask:0xf
    v_and_b32_dpp v45, v56, v4 quad_perm:[2,2,2,2] row_mask:0xf bank_mask:0xf
    v_and_b32_dpp v46, v56, v3 quad_perm:[3,3,3,3] row_mask:0xf bank_mask:0xf
    v_and_b32_dpp v47, v56, v4 quad_perm:[3,3,3,3] row_mask:0xf bank_mask:0xf
    v_mfma_f32_4x4x4_16b_bf16 v[24:27], v[64:65], v[40:41], v[24:27]
    v_mfma_f32_4x4x4_16b_bf16 v[28:31], v[66:67], v[40:41], v[28:31]
    v_mfma_f32_4x4x4_16b_bf16 v[32:35], v[68:69], v[40:41], v[32:35]
    v_mfma_f32_4x4x4_16b_bf16 v[36:39], v[70:71], v[40:41], v[36:39]
    v_mfma_f32_4x4x4_16b_bf16 v[24:27], v[72:73], v[42:43], v[24:27]
    v_mfma_f32_4x4x4_16b_bf16 v[28:31], v[74:75], v[42:43], v[28:31]
    v_mfma_f32_4x4x4_16b_bf16 v[32:35], v[76:77], v[42:43], v[32:35]
    v_mfma_f32_4x4x4_16b_bf16 v[36:39], v[78:79], v[42:43], v[36:39]
    v_mfma_f32_4x4x4_16b_bf16 v[24:27], v[80:81], v[44:45], v[24:27]
    v_mfma_f32_4x4x4_16b_bf16 v[28:31], v[82:83], v[44:45], v[28:31]
    v_mfma_f32_4x4x4_16b_bf16 v[32:35], v[84:85], v[44:45], v[32:35]
    v_mfma_f32_4x4x4_16b_bf16 v[36:39], v[86:87], v[44:45], v[36:39]
    v_mfma_f32_4x4x4_16b_bf16 v[24:27], v[88:89], v[46:47], v[24:27]
    v_mfma_f32_4x4x4_16b_bf16 v[28:31], v[90:91], v[46:47], v[28:31]
    v_mfma_f32_4x4x4_16b_bf16 v[32:35], v[92:93], v[46:47], v[32:35]
    v_mfma_f32_4x4x4_16b_bf16 v[36:39], v[94:95], v[46:47], v[36:39]
    buffer_load_dwordx4 v[64:67], v8, s[12:15], 0 offen
    buffer_load_dwordx4 v[68:71], v8, s[12:15], 0 offen offset:64
    buffer_load_dwordx4 v[72:75], v9, s[12:15], 0 offen
    buffer_load_dwordx4 v[76:79], v9, s[12:15], 0 offen offset:64
    buffer_load_dwordx4 v[80:83], v10, s[12:15], 0 offen
    buffer_load_dwordx4 v[84:87], v10, s[12:15], 0 offen offset:64
    buffer_load_dwordx4 v[88:91], v11, s[12:15], 0 offen
    buffer_load_dwordx4 v[92:95], v11, s[12:15], 0 offen offset:64
K_loop1:
    s_waitcnt vmcnt(8)
K_go1:
    s_cmp_lt_u32 s36, 2
    s_cbranch_scc1 K_pen1
    ds_read2_b32 v[8:9], v57 offset0:0 offset1:4
    ds_read2_b32 v[10:11], v57 offset0:8 offset1:12
    v_add_u32 v57, s41, v57
    s_sub_u32 s36, s36, 1
    .p2align 3
    v_mfma_f32_4x4x4_16b_bf16 v[40:43], v[96:97], v[16:17], 0
    v_mfma_f32_4x4x4_16b_bf16 v[44:47], v[104:105], v[16:17], 0
    v_mfma_f32_4x4x4_16b_bf16 v[48:51], v[112:113], v[16:17], 0
    v_mfma_f32_4x4x4_16b_bf16 v[52:55], v[120:121], v[16:17], 0
    v_mfma_f32_4x4x4_16b_bf16 v[40:43], v[98:99], v[18:19], v[40:43]
    v_mfma_f32_4x4x4_16b_bf16 v[44:47], v[106:107], v[18:19], v[44:47]
    v_mfma_f32_4x4x4_16b_bf16 v[48:51], v[114:115], v[18:19], v[48:51]
    v_mfma_f32_4x4x4_16b_bf16 v[52:55], v[122:123], v[18:19], v[52:55]
    v_mfma_f32_4x4x4_16b_bf16 v[40:43], v[100:101], v[20:21], v[40:43]
    v_mfma_f32_4x4x4_16b_bf16 v[44:47], v[108:109], v[20:21], v[44:47]
    v_mfma_f32_4x4x4_16b_bf16 v[48:51], v[116:117], v[20:21], v[48:51]
    v_mfma_f32_4x4x4_16b_bf16 v[52:55], v[124:125], v[20:21], v[52:55]
    v_mfma_f32_4x4x4_16b_bf16 v[40:43], v[102:103], v[22:23], v[40:43]
    v_mfma_f32_4x4x4_16b_bf16 v[44:47], v[110:111], v[22:23], v[44:47]
    v_mfma_f32_4x4x4_16b_bf16 v[48:51], v[118:119], v[22:23], v[48:51]
    v_mfma_f32_4x4x4_16b_bf16 v[52:55], v[126:127], v[22:23], v[52:55]
    s_waitcnt lgkmcnt(0)
    v_add_u32 v8, v8, v6
    v_add_f32_dpp v40, v41, v40 quad_perm:[1,1,1,1] row_mask:0xf bank_mask:0xf
    v_add_f32_dpp v45, v44, v45 quad_perm:[0,0,0,0] row_mask:0xf bank_mask:0xf
    v_add_f32_dpp v50, v48, v50 quad_perm:[0,0,0,0] row_mask:0xf bank_mask:0xf
    v_add_f32_dpp v55, v52, v55 quad_perm:[0,0,0,0] row_mask:0xf bank_mask:0xf
    v_add_f32_dpp v40, v42, v40 quad_perm:[2,2,2,2] row_mask:0xf bank_mask:0xf
    v_add_f32_dpp v45, v46, v45 quad_perm:[2,2,2,2] row_mask:0xf bank_mask:0xf
    v_add_f32_dpp v50, v49, v50 quad_perm:[1,1,1,1] row_mask:0xf bank_mask:0xf
    v_add_f32_dpp v55, v53, v55 quad_perm:[1,1,1,1] row_mask:0xf bank_mask:0xf
    v_add_f32_dpp v40, v43, v40 quad_perm:[3,3,3,3] row_mask:0xf bank_mask:0xf
    v_add_f32_dpp v45, v47, v45 quad_perm:[3,3,3,3] row_mask:0xf bank_mask:0xf
    v_add_f32_dpp v50, v51, v50 quad_perm:[3,3,3,3] row_mask:0xf bank_mask:0xf
    v_add_f32_dpp v55, v54, v55 quad_perm:[2,2,2,2] row_mask:0xf bank_mask:0xf
    v_cndmask_b32 v40, v40, v45, s[22:23]
    v_cndmask_b32 v50, v50, v55, s[22:23]
    v_cndmask_b32 v56, v40, v50, s[28:29]
    v_mul_f32 v56, s30, v56
    v_exp_f32 v56, v56
    v_add_u32 v9, v9, v6
    v_add_f32 v56, 1.0, v56
    v_rcp_f32 v56, v56
    v_add_u32 v10, v10, v6
    v_cvt_pk_bf16_f32 v56, v56, v56
    s_nop 0
    v_add_u32 v11, v11, v6
    v_and_b32_dpp v40, v56, v3 quad_perm:[0,0,0,0] row_mask:0xf bank_mask:0xf
    v_and_b32_dpp v41, v56, v4 quad_perm:[0,0,0,0] row_mask:0xf bank_mask:0xf
    v_and_b32_dpp v42, v56, v3 quad_perm:[1,1,1,1] row_mask:0xf bank_mask:0xf
    v_and_b32_dpp v43, v56, v4 quad_perm:[1,1,1,1] row_mask:0xf bank_mask:0xf
    v_and_b32_dpp v44, v56, v3 quad_perm:[2,2,2,2] row_mask:0xf bank_mask:0xf
    v_and_b32_dpp v45, v56, v4 quad_perm:[2,2,2,2] row_mask:0xf bank_mask:0xf
    v_and_b32_dpp v46, v56, v3 quad_perm:[3,3,3,3] row_mask:0xf bank_mask:0xf
    v_and_b32_dpp v47, v56, v4 quad_perm:[3,3,3,3] row_mask:0xf bank_mask:0xf
    v_mfma_f32_4x4x4_16b_bf16 v[24:27], v[96:97], v[40:41], v[24:27]
    v_mfma_f32_4x4x4_16b_bf16 v[28:31], v[98:99], v[40:41], v[28:31]
    v_mfma_f32_4x4x4_16b_bf16 v[32:35], v[100:101], v[40:41], v[32:35]
    v_mfma_f32_4x4x4_16b_bf16 v[36:39], v[102:103], v[40:41], v[36:39]
    v_mfma_f32_4x4x4_16b_bf16 v[24:27], v[104:105], v[42:43], v[24:27]
    v_mfma_f32_4x4x4_16b_bf16 v[28:31], v[106:107], v[42:43], v[28:31]
    v_mfma_f32_4x4x4_16b_bf16 v[32:35], v[108:109], v[42:43], v[32:35]
    v_mfma_f32_4x4x4_16b_bf16 v[36:39], v[110:111], v[42:43], v[36:39]
    v_mfma_f32_4x4x4_16b_bf16 v[24:27], v[112:113], v[44:45], v[24:27]
    v_mfma_f32_4x4x4_16b_bf16 v[28:31], v[114:115], v[44:45], v[28:31]
    v_mfma_f32_4x4x4_16b_bf16 v[32:35], v[116:117], v[44:45], v[32:35]
    v_mfma_f32_4x4x4_16b_bf16 v[36:39], v[118:119], v[44:45], v[36:39]
    v_mfma_f32_4x4x4_16b_bf16 v[24:27], v[120:121], v[46:47], v[24:27]
    v_mfma_f32_4x4x4_16b_bf16 v[28:31], v[122:123], v[46:47], v[28:31]
    v_mfma_f32_4x4x4_16b_bf16 v[32:35], v[124:125], v[46:47], v[32:35]
    v_mfma_f32_4x4x4_16b_bf16 v[36:39], v[126:127], v[46:47], v[36:39]
    buffer_load_dwordx4 v[96:99], v8, s[12:15], 0 offen
    buffer_load_dwordx4 v[100:103], v8, s[12:15], 0 offen offset:64
    buffer_load_dwordx4 v[104:107], v9, s[12:15], 0 offen
    buffer_load_dwordx4 v[108:111], v9, s[12:15], 0 offen offset:64
    buffer_load_dwordx4 v[112:115], v10, s[12:15], 0 offen
    buffer_load_dwordx4 v[116:119], v10, s[12:15], 0 offen offset:64
    buffer_load_dwordx4 v[120:123], v11, s[12:15], 0 offen
    buffer_load_dwordx4 v[124:127], v11, s[12:15], 0 offen offset:64
    s_branch K_loop0
K_pen0:
    .p2align 3
    v_mfma_f32_4x4x4_16b_bf16 v[40:43], v[64:65], v[16:17], 0
    v_mfma_f32_4x4x4_16b_bf16 v[44:47], v[72:73], v[16:17], 0
    v_mfma_f32_4x4x4_16b_bf16 v[48:51], v[80:81], v[16:17], 0
    v_mfma_f32_4x4x4_16b_bf16 v[52:55], v[88:89], v[16:17], 0
    v_mfma_f32_4x4x4_16b_bf16 v[40:43], v[66:67], v[18:19], v[40:43]
    v_mfma_f32_4x4x4_16b_bf16 v[44:47], v[74:75], v[18:19], v[44:47]
    v_mfma_f32_4x4x4_16b_bf16 v[48:51], v[82:83], v[18:19], v[48:51]
    v_mfma_f32_4x4x4_16b_bf16 v[52:55], v[90:91], v[18:19], v[52:55]
    v_mfma_f32_4x4x4_16b_bf16 v[40:43], v[68:69], v[20:21], v[40:43]
    v_mfma_f32_4x4x4_16b_bf16 v[44:47], v[76:77], v[20:21], v[44:47]
    v_mfma_f32_4x4x4_16b_bf16 v[48:51], v[84:85], v[20:21], v[48:51]
    v_mfma_f32_4x4x4_16b_bf16 v[52:55], v[92:93], v[20:21], v[52:55]
    v_mfma_f32_4x4x4_16b_bf16 v[40:43], v[70:71], v[22:23], v[40:43]
    v_mfma_f32_4x4x4_16b_bf16 v[44:47], v[78:79], v[22:23], v[44:47]
    v_mfma_f32_4x4x4_16b_bf16 v[48:51], v[86:87], v[22:23], v[48:51]
    v_mfma_f32_4x4x4_16b_bf16 v[52:55], v[94:95], v[22:23], v[52:55]
    s_nop 0
    s_nop 0
    v_add_f32_dpp v40, v41, v40 quad_perm:[1,1,1,1] row_mask:0xf bank_mask:0xf
    v_add_f32_dpp v45, v44, v45 quad_perm:[0,0,0,0] row_mask:0xf bank_mask:0xf
    v_add_f32_dpp v50, v48, v50 quad_perm:[0,0,0,0] row_mask:0xf bank_mask:0xf
    v_add_f32_dpp v55, v52, v55 quad_perm:[0,0,0,0] row_mask:0xf bank_mask:0xf
    v_add_f32_dpp v40, v42, v40 quad_perm:[2,2,2,2] row_mask:0xf bank_mask:0xf
    v_add_f32_dpp v45, v46, v45 quad_perm:[2,2,2,2] row_mask:0xf bank_mask:0xf
    v_add_f32_dpp v50, v49, v50 quad_perm:[1,1,1,1] row_mask:0xf bank_mask:0xf
    v_add_f32_dpp v55, v53, v55 quad_perm:[1,1,1,1] row_mask:0xf bank_mask:0xf
    v_add_f32_dpp v40, v43, v40 quad_perm:[3,3,3,3] row_mask:0xf bank_mask:0xf
    v_add_f32_dpp v45, v47, v45 quad_perm:[3,3,3,3] row_mask:0xf bank_mask:0xf
    v_add_f32_dpp v50, v51, v50 quad_perm:[3,3,3,3] row_mask:0xf bank_mask:0xf
    v_add_f32_dpp v55, v54, v55 quad_perm:[2,2,2,2] row_mask:0xf bank_mask:0xf
    v_cndmask_b32 v40, v40, v45, s[22:23]
    v_cndmask_b32 v50, v50, v55, s[22:23]
    v_cndmask_b32 v56, v40, v50, s[28:29]
    v_mul_f32 v56, s30, v56
    v_exp_f32 v56, v56
    s_nop 0
    v_add_f32 v56, 1.0, v56
    v_rcp_f32 v56, v56
    s_nop 0
    v_cvt_pk_bf16_f32 v56, v56, v56
    s_nop 0
    s_nop 0
    v_and_b32_dpp v40, v56, v3 quad_perm:[0,0,0,0] row_mask:0xf bank_mask:0xf
    v_and_b32_dpp v41, v56, v4 quad_perm:[0,0,0,0] row_mask:0xf bank_mask:0xf
    v_and_b32_dpp v42, v56, v3 quad_perm:[1,1,1,1] row_mask:0xf bank_mask:0xf
    v_and_b32_dpp v43, v56, v4 quad_perm:[1,1,1,1] row_mask:0xf bank_mask:0xf
    v_and_b32_dpp v44, v56, v3 quad_perm:[2,2,2,2] row_mask:0xf bank_mask:0xf
    v_and_b32_dpp v45, v56, v4 quad_perm:[2,2,2,2] row_mask:0xf bank_mask:0xf
    v_and_b32_dpp v46, v56, v3 quad_perm:[3,3,3,3] row_mask:0xf bank_mask:0xf
    v_and_b32_dpp v47, v56, v4 quad_perm:[3,3,3,3] row_mask:0xf bank_mask:0xf
    v_mfma_f32_4x4x4_16b_bf16 v[24:27], v[64:65], v[40:41], v[24:27]
    v_mfma_f32_4x4x4_16b_bf16 v[28:31], v[66:67], v[40:41], v[28:31]
    v_mfma_f32_4x4x4_16b_bf16 v[32:35], v[68:69], v[40:41], v[32:35]
    v_mfma_f32_4x4x4_16b_bf16 v[36:39], v[70:71], v[40:41], v[36:39]
    v_mfma_f32_4x4x4_16b_bf16 v[24:27], v[72:73], v[42:43], v[24:27]
    v_mfma_f32_4x4x4_16b_bf16 v[28:31], v[74:75], v[42:43], v[28:31]
    v_mfma_f32_4x4x4_16b_bf16 v[32:35], v[76:77], v[42:43], v[32:35]
    v_mfma_f32_4x4x4_16b_bf16 v[36:39], v[78:79], v[42:43], v[36:39]
    v_mfma_f32_4x4x4_16b_bf16 v[24:27], v[80:81], v[44:45], v[24:27]
    v_mfma_f32_4x4x4_16b_bf16 v[28:31], v[82:83], v[44:45], v[28:31]
    v_mfma_f32_4x4x4_16b_bf16 v[32:35], v[84:85], v[44:45], v[32:35]
    v_mfma_f32_4x4x4_16b_bf16 v[36:39], v[86:87], v[44:45], v[36:39]
    v_mfma_f32_4x4x4_16b_bf16 v[24:27], v[88:89], v[46:47], v[24:27]
    v_mfma_f32_4x4x4_16b_bf16 v[28:31], v[90:91], v[46:47], v[28:31]
    v_mfma_f32_4x4x4_16b_bf16 v[32:35], v[92:93], v[46:47], v[32:35]
    v_mfma_f32_4x4x4_16b_bf16 v[36:39], v[94:95], v[46:47], v[36:39]
    s_branch K_last1
K_pen1:
    .p2align 3
    v_mfma_f32_4x4x4_16b_bf16 v[40:43], v[96:97], v[16:17], 0
    v_mfma_f32_4x4x4_16b_bf16 v[44:47], v[104:105], v[16:17], 0
    v_mfma_f32_4x4x4_16b_bf16 v[48:51], v[112:113], v[16:17], 0
    v_mfma_f32_4x4x4_16b_bf16 v[52:55], v[120:121], v[16:17], 0
    v_mfma_f32_4x4x4_16b_bf16 v[40:43], v[98:99], v[18:19], v[40:43]
    v_mfma_f32_4x4x4_16b_bf16 v[44:47], v[106:107], v[18:19], v[44:47]
    v_mfma_f32_4x4x4_16b_bf16 v[48:51], v[114:115], v[18:19], v[48:51]
    v_mfma_f32_4x4x4_16b_bf16 v[52:55], v[122:123], v[18:19], v[52:55]
    v_mfma_f32_4x4x4_16b_bf16 v[40:43], v[100:101], v[20:21], v[40:43]
    v_mfma_f32_4x4x4_16b_bf16 v[44:47], v[108:109], v[20:21], v[44:47]
    v_mfma_f32_4x4x4_16b_bf16 v[48:51], v[116:117], v[20:21], v[48:51]
    v_mfma_f32_4x4x4_16b_bf16 v[52:55], v[124:125], v[20:21], v[52:55]
    v_mfma_f32_4x4x4_16b_bf16 v[40:43], v[102:103], v[22:23], v[40:43]
    v_mfma_f32_4x4x4_16b_bf16 v[44:47], v[110:111], v[22:23], v[44:47]
    v_mfma_f32_4x4x4_16b_bf16 v[48:51], v[118:119], v[22:23], v[48:51]
    v_mfma_f32_4x4x4_16b_bf16 v[52:55], v[126:127], v[22:23], v[52:55]
    s_nop 0
    s_nop 0
    v_add_f32_dpp v40, v41, v40 quad_perm:[1,1,1,1] row_mask:0xf bank_mask:0xf
    v_add_f32_dpp v45, v44, v45 quad_perm:[0,0,0,0] row_mask:0xf bank_mask:0xf
    v_add_f32_dpp v50, v48, v50 quad_perm:[0,0,0,0] row_mask:0xf bank_mask:0xf
    v_add_f32_dpp v55, v52, v55 quad_perm:[0,0,0,0] row_mask:0xf bank_mask:0xf
    v_add_f32_dpp v40, v42, v40 quad_perm:[2,2,2,2] row_mask:0xf bank_mask:0xf
    v_add_f32_dpp v45, v46, v45 quad_perm:[2,2,2,2] row_mask:0xf bank_mask:0xf
    v_add_f32_dpp v50, v49, v50 quad_perm:[1,1,1,1] row_mask:0xf bank_mask:0xf
    v_add_f32_dpp v55, v53, v55 quad_perm:[1,1,1,1] row_mask:0xf bank_mask:0xf
    v_add_f32_dpp v40, v43, v40 quad_perm:[3,3,3,3] row_mask:0xf bank_mask:0xf
    v_add_f32_dpp v45, v47, v45 quad_perm:[3,3,3,3] row_mask:0xf bank_mask:0xf
    v_add_f32_dpp v50, v51, v50 quad_perm:[3,3,3,3] row_mask:0xf bank_mask:0xf
    v_add_f32_dpp v55, v54, v55 quad_perm:[2,2,2,2] row_mask:0xf bank_mask:0xf
    v_cndmask_b32 v40, v40, v45, s[22:23]
    v_cndmask_b32 v50, v50, v55, s[22:23]
    v_cndmask_b32 v56, v40, v50, s[28:29]
    v_mul_f32 v56, s30, v56
    v_exp_f32 v56, v56
    s_nop 0
    v_add_f32 v56, 1.0, v56
    v_rcp_f32 v56, v56
    s_nop 0
    v_cvt_pk_bf16_f32 v56, v56, v56
    s_nop 0
    s_nop 0
    v_and_b32_dpp v40, v56, v3 quad_perm:[0,0,0,0] row_mask:0xf bank_mask:0xf
    v_and_b32_dpp v41, v56, v4 quad_perm:[0,0,0,0] row_mask:0xf bank_mask:0xf
    v_and_b32_dpp v42, v56, v3 quad_perm:[1,1,1,1] row_mask:0xf bank_mask:0xf
    v_and_b32_dpp v43, v56, v4 quad_perm:[1,1,1,1] row_mask:0xf bank_mask:0xf
    v_and_b32_dpp v44, v56, v3 quad_perm:[2,2,2,2] row_mask:0xf bank_mask:0xf
    v_and_b32_dpp v45, v56, v4 quad_perm:[2,2,2,2] row_mask:0xf bank_mask:0xf
    v_and_b32_dpp v46, v56, v3 quad_perm:[3,3,3,3] row_mask:0xf bank_mask:0xf
    v_and_b32_dpp v47, v56, v4 quad_perm:[3,3,3,3] row_mask:0xf bank_mask:0xf
    v_mfma_f32_4x4x4_16b_bf16 v[24:27], v[96:97], v[40:41], v[24:27]
    v_mfma_f32_4x4x4_16b_bf16 v[28:31], v[98:99], v[40:41], v[28:31]
    v_mfma_f32_4x4x4_16b_bf16 v[32:35], v[100:101], v[40:41], v[32:35]
    v_mfma_f32_4x4x4_16b_bf16 v[36:39], v[102:103], v[40:41], v[36:39]
    v_mfma_f32_4x4x4_16b_bf16 v[24:27], v[104:105], v[42:43], v[24:27]
    v_mfma_f32_4x4x4_16b_bf16 v[28:31], v[106:107], v[42:43], v[28:31]
    v_mfma_f32_4x4x4_16b_bf16 v[32:35], v[108:109], v[42:43], v[32:35]
    v_mfma_f32_4x4x4_16b_bf16 v[36:39], v[110:111], v[42:43], v[36:39]
    v_mfma_f32_4x4x4_16b_bf16 v[24:27], v[112:113], v[44:45], v[24:27]
    v_mfma_f32_4x4x4_16b_bf16 v[28:31], v[114:115], v[44:45], v[28:31]
    v_mfma_f32_4x4x4_16b_bf16 v[32:35], v[116:117], v[44:45], v[32:35]
    v_mfma_f32_4x4x4_16b_bf16 v[36:39], v[118:119], v[44:45], v[36:39]
    v_mfma_f32_4x4x4_16b_bf16 v[24:27], v[120:121], v[46:47], v[24:27]
    v_mfma_f32_4x4x4_16b_bf16 v[28:31], v[122:123], v[46:47], v[28:31]
    v_mfma_f32_4x4x4_16b_bf16 v[32:35], v[124:125], v[46:47], v[32:35]
    v_mfma_f32_4x4x4_16b_bf16 v[36:39], v[126:127], v[46:47], v[36:39]
    s_branch K_last0
K_last0:
    s_waitcnt vmcnt(0) lgkmcnt(0)
    .p2align 3
    v_mfma_f32_4x4x4_16b_bf16 v[40:43], v[64:65], v[16:17], 0
    v_mfma_f32_4x4x4_16b_bf16 v[44:47], v[72:73], v[16:17], 0
    v_mfma_f32_4x4x4_16b_bf16 v[48:51], v[80:81], v[16:17], 0
    v_mfma_f32_4x4x4_16b_bf16 v[52:55], v[88:89], v[16:17], 0
    v_mfma_f32_4x4x4_16b_bf16 v[40:43], v[66:67], v[18:19], v[40:43]
    v_mfma_f32_4x4x4_16b_bf16 v[44:47], v[74:75], v[18:19], v[44:47]
    v_mfma_f32_4x4x4_16b_bf16 v[48:51], v[82:83], v[18:19], v[48:51]
    v_mfma_f32_4x4x4_16b_bf16 v[52:55], v[90:91], v[18:19], v[52:55]
    v_mfma_f32_4x4x4_16b_bf16 v[40:43], v[68:69], v[20:21], v[40:43]
    v_mfma_f32_4x4x4_16b_bf16 v[44:47], v[76:77], v[20:21], v[44:47]
    v_mfma_f32_4x4x4_16b_bf16 v[48:51], v[84:85], v[20:21], v[48:51]
    v_mfma_f32_4x4x4_16b_bf16 v[52:55], v[92:93], v[20:21], v[52:55]
    v_mfma_f32_4x4x4_16b_bf16 v[40:43], v[70:71], v[22:23], v[40:43]
    v_mfma_f32_4x4x4_16b_bf16 v[44:47], v[78:79], v[22:23], v[44:47]
    v_mfma_f32_4x4x4_16b_bf16 v[48:51], v[86:87], v[22:23], v[48:51]
    v_mfma_f32_4x4x4_16b_bf16 v[52:55], v[94:95], v[22:23], v[52:55]
    s_nop 0
    s_nop 0
    v_add_f32_dpp v40, v41, v40 quad_perm:[1,1,1,1] row_mask:0xf bank_mask:0xf
    v_add_f32_dpp v45, v44, v45 quad_perm:[0,0,0,0] row_mask:0xf bank_mask:0xf
    v_add_f32_dpp v50, v48, v50 quad_perm:[0,0,0,0] row_mask:0xf bank_mask:0xf
    v_add_f32_dpp v55, v52, v55 quad_perm:[0,0,0,0] row_mask:0xf bank_mask:0xf
    v_add_f32_dpp v40, v42, v40 quad_perm:[2,2,2,2] row_mask:0xf bank_mask:0xf
    v_add_f32_dpp v45, v46, v45 quad_perm:[2,2,2,2] row_mask:0xf bank_mask:0xf
    v_add_f32_dpp v50, v49, v50 quad_perm:[1,1,1,1] row_mask:0xf bank_mask:0xf
    v_add_f32_dpp v55, v53, v55 quad_perm:[1,1,1,1] row_mask:0xf bank_mask:0xf
    v_add_f32_dpp v40, v43, v40 quad_perm:[3,3,3,3] row_mask:0xf bank_mask:0xf
    v_add_f32_dpp v45, v47, v45 quad_perm:[3,3,3,3] row_mask:0xf bank_mask:0xf
    v_add_f32_dpp v50, v51, v50 quad_perm:[3,3,3,3] row_mask:0xf bank_mask:0xf
    v_add_f32_dpp v55, v54, v55 quad_perm:[2,2,2,2] row_mask:0xf bank_mask:0xf
    v_cndmask_b32 v40, v40, v45, s[22:23]
    v_cndmask_b32 v50, v50, v55, s[22:23]
    v_cndmask_b32 v56, v40, v50, s[28:29]
    v_mul_f32 v56, s30, v56
    v_exp_f32 v56, v56
    s_nop 0
    v_add_f32 v56, 1.0, v56
    v_rcp_f32 v56, v56
    s_nop 0
    v_cvt_pk_bf16_f32 v56, v56, v56
    s_nop 0
    s_nop 0
    v_and_b32_dpp v40, v56, v3 quad_perm:[0,0,0,0] row_mask:0xf bank_mask:0xf
    v_and_b32_dpp v41, v56, v4 quad_perm:[0,0,0,0] row_mask:0xf bank_mask:0xf
    v_and_b32_dpp v42, v56, v3 quad_perm:[1,1,1,1] row_mask:0xf bank_mask:0xf
    v_and_b32_dpp v43, v56, v4 quad_perm:[1,1,1,1] row_mask:0xf bank_mask:0xf
    v_and_b32_dpp v44, v56, v3 quad_perm:[2,2,2,2] row_mask:0xf bank_mask:0xf
    v_and_b32_dpp v45, v56, v4 quad_perm:[2,2,2,2] row_mask:0xf bank_mask:0xf
    v_and_b32_dpp v46, v56, v3 quad_perm:[3,3,3,3] row_mask:0xf bank_mask:0xf
    v_and_b32_dpp v47, v56, v4 quad_perm:[3,3,3,3] row_mask:0xf bank_mask:0xf
    v_mfma_f32_4x4x4_16b_bf16 v[24:27], v[64:65], v[40:41], v[24:27]
    v_mfma_f32_4x4x4_16b_bf16 v[28:31], v[66:67], v[40:41], v[28:31]
    v_mfma_f32_4x4x4_16b_bf16 v[32:35], v[68:69], v[40:41], v[32:35]
    v_mfma_f32_4x4x4_16b_bf16 v[36:39], v[70:71], v[40:41], v[36:39]
    v_mfma_f32_4x4x4_16b_bf16 v[24:27], v[72:73], v[42:43], v[24:27]
    v_mfma_f32_4x4x4_16b_bf16 v[28:31], v[74:75], v[42:43], v[28:31]
    v_mfma_f32_4x4x4_16b_bf16 v[32:35], v[76:77], v[42:43], v[32:35]
    v_mfma_f32_4x4x4_16b_bf16 v[36:39], v[78:79], v[42:43], v[36:39]
    v_mfma_f32_4x4x4_16b_bf16 v[24:27], v[80:81], v[44:45], v[24:27]
    v_mfma_f32_4x4x4_16b_bf16 v[28:31], v[82:83], v[44:45], v[28:31]
    v_mfma_f32_4x4x4_16b_bf16 v[32:35], v[84:85], v[44:45], v[32:35]
    v_mfma_f32_4x4x4_16b_bf16 v[36:39], v[86:87], v[44:45], v[36:39]
    v_mfma_f32_4x4x4_16b_bf16 v[24:27], v[88:89], v[46:47], v[24:27]
    v_mfma_f32_4x4x4_16b_bf16 v[28:31], v[90:91], v[46:47], v[28:31]
    v_mfma_f32_4x4x4_16b_bf16 v[32:35], v[92:93], v[46:47], v[32:35]
    v_mfma_f32_4x4x4_16b_bf16 v[36:39], v[94:95], v[46:47], v[36:39]
    s_branch K_rdone
K_last1:
    s_waitcnt vmcnt(0) lgkmcnt(0)
    .p2align 3
    v_mfma_f32_4x4x4_16b_bf16 v[40:43], v[96:97], v[16:17], 0
    v_mfma_f32_4x4x4_16b_bf16 v[44:47], v[104:105], v[16:17], 0
    v_mfma_f32_4x4x4_16b_bf16 v[48:51], v[112:113], v[16:17], 0
    v_mfma_f32_4x4x4_16b_bf16 v[52:55], v[120:121], v[16:17], 0
    v_mfma_f32_4x4x4_16b_bf16 v[40:43], v[98:99], v[18:19], v[40:43]
    v_mfma_f32_4x4x4_16b_bf16 v[44:47], v[106:107], v[18:19], v[44:47]
    v_mfma_f32_4x4x4_16b_bf16 v[48:51], v[114:115], v[18:19], v[48:51]
    v_mfma_f32_4x4x4_16b_bf16 v[52:55], v[122:123], v[18:19], v[52:55]
    v_mfma_f32_4x4x4_16b_bf16 v[40:43], v[100:101], v[20:21], v[40:43]
    v_mfma_f32_4x4x4_16b_bf16 v[44:47], v[108:109], v[20:21], v[44:47]
    v_mfma_f32_4x4x4_16b_bf16 v[48:51], v[116:117], v[20:21], v[48:51]
    v_mfma_f32_4x4x4_16b_bf16 v[52:55], v[124:125], v[20:21], v[52:55]
    v_mfma_f32_4x4x4_16b_bf16 v[40:43], v[102:103], v[22:23], v[40:43]
    v_mfma_f32_4x4x4_16b_bf16 v[44:47], v[110:111], v[22:23], v[44:47]
    v_mfma_f32_4x4x4_16b_bf16 v[48:51], v[118:119], v[22:23], v[48:51]
    v_mfma_f32_4x4x4_16b_bf16 v[52:55], v[126:127], v[22:23], v[52:55]
    s_nop 0
    s_nop 0
    v_add_f32_dpp v40, v41, v40 quad_perm:[1,1,1,1] row_mask:0xf bank_mask:0xf
    v_add_f32_dpp v45, v44, v45 quad_perm:[0,0,0,0] row_mask:0xf bank_mask:0xf
    v_add_f32_dpp v50, v48, v50 quad_perm:[0,0,0,0] row_mask:0xf bank_mask:0xf
    v_add_f32_dpp v55, v52, v55 quad_perm:[0,0,0,0] row_mask:0xf bank_mask:0xf
    v_add_f32_dpp v40, v42, v40 quad_perm:[2,2,2,2] row_mask:0xf bank_mask:0xf
    v_add_f32_dpp v45, v46, v45 quad_perm:[2,2,2,2] row_mask:0xf bank_mask:0xf
    v_add_f32_dpp v50, v49, v50 quad_perm:[1,1,1,1] row_mask:0xf bank_mask:0xf
    v_add_f32_dpp v55, v53, v55 quad_perm:[1,1,1,1] row_mask:0xf bank_mask:0xf
    v_add_f32_dpp v40, v43, v40 quad_perm:[3,3,3,3] row_mask:0xf bank_mask:0xf
    v_add_f32_dpp v45, v47, v45 quad_perm:[3,3,3,3] row_mask:0xf bank_mask:0xf
    v_add_f32_dpp v50, v51, v50 quad_perm:[3,3,3,3] row_mask:0xf bank_mask:0xf
    v_add_f32_dpp v55, v54, v55 quad_perm:[2,2,2,2] row_mask:0xf bank_mask:0xf
    v_cndmask_b32 v40, v40, v45, s[22:23]
    v_cndmask_b32 v50, v50, v55, s[22:23]
    v_cndmask_b32 v56, v40, v50, s[28:29]
    v_mul_f32 v56, s30, v56
    v_exp_f32 v56, v56
    s_nop 0
    v_add_f32 v56, 1.0, v56
    v_rcp_f32 v56, v56
    s_nop 0
    v_cvt_pk_bf16_f32 v56, v56, v56
    s_nop 0
    s_nop 0
    v_and_b32_dpp v40, v56, v3 quad_perm:[0,0,0,0] row_mask:0xf bank_mask:0xf
    v_and_b32_dpp v41, v56, v4 quad_perm:[0,0,0,0] row_mask:0xf bank_mask:0xf
    v_and_b32_dpp v42, v56, v3 quad_perm:[1,1,1,1] row_mask:0xf bank_mask:0xf
    v_and_b32_dpp v43, v56, v4 quad_perm:[1,1,1,1] row_mask:0xf bank_mask:0xf
    v_and_b32_dpp v44, v56, v3 quad_perm:[2,2,2,2] row_mask:0xf bank_mask:0xf
    v_and_b32_dpp v45, v56, v4 quad_perm:[2,2,2,2] row_mask:0xf bank_mask:0xf
    v_and_b32_dpp v46, v56, v3 quad_perm:[3,3,3,3] row_mask:0xf bank_mask:0xf
    v_and_b32_dpp v47, v56, v4 quad_perm:[3,3,3,3] row_mask:0xf bank_mask:0xf
    v_mfma_f32_4x4x4_16b_bf16 v[24:27], v[96:97], v[40:41], v[24:27]
    v_mfma_f32_4x4x4_16b_bf16 v[28:31], v[98:99], v[40:41], v[28:31]
    v_mfma_f32_4x4x4_16b_bf16 v[32:35], v[100:101], v[40:41], v[32:35]
    v_mfma_f32_4x4x4_16b_bf16 v[36:39], v[102:103], v[40:41], v[36:39]
    v_mfma_f32_4x4x4_16b_bf16 v[24:27], v[104:105], v[42:43], v[24:27]
    v_mfma_f32_4x4x4_16b_bf16 v[28:31], v[106:107], v[42:43], v[28:31]
    v_mfma_f32_4x4x4_16b_bf16 v[32:35], v[108:109], v[42:43], v[32:35]
    v_mfma_f32_4x4x4_16b_bf16 v[36:39], v[110:111], v[42:43], v[36:39]
    v_mfma_f32_4x4x4_16b_bf16 v[24:27], v[112:113], v[44:45], v[24:27]
    v_mfma_f32_4x4x4_16b_bf16 v[28:31], v[114:115], v[44:45], v[28:31]
    v_mfma_f32_4x4x4_16b_bf16 v[32:35], v[116:117], v[44:45], v[32:35]
    v_mfma_f32_4x4x4_16b_bf16 v[36:39], v[118:119], v[44:45], v[36:39]
    v_mfma_f32_4x4x4_16b_bf16 v[24:27], v[120:121], v[46:47], v[24:27]
    v_mfma_f32_4x4x4_16b_bf16 v[28:31], v[122:123], v[46:47], v[28:31]
    v_mfma_f32_4x4x4_16b_bf16 v[32:35], v[124:125], v[46:47], v[32:35]
    v_mfma_f32_4x4x4_16b_bf16 v[36:39], v[126:127], v[46:47], v[36:39]
K_rdone:
    s_or_b32 s35, s34, s38
    s_cmp_lg_u32 s35, 0
    s_cbranch_scc1 K_more
    s_cmp_gt_u32 s16, 12
    s_cbranch_scc1 K_epi
    v_mul_u32_u24 v56, 144, v7
    v_and_b32 v57, 15, v0
    v_lshl_add_u32 v56, v57, 3, v56
    s_nop 1
    v_add_f32_dpp v24, v24, v24 row_ror:8 row_mask:0xf bank_mask:0x3
    v_add_f32_dpp v25, v25, v25 row_ror:8 row_mask:0xf bank_mask:0x3
    v_add_f32_dpp v26, v26, v26 row_ror:8 row_mask:0xf bank_mask:0x3
    v_add_f32_dpp v27, v27, v27 row_ror:8 row_mask:0xf bank_mask:0x3
    v_add_f32_dpp v28, v28, v28 row_ror:8 row_mask:0xf bank_mask:0x3
    v_add_f32_dpp v29, v29, v29 row_ror:8 row_mask:0xf bank_mask:0x3
    v_add_f32_dpp v30, v30, v30 row_ror:8 row_mask:0xf bank_mask:0x3
    v_add_f32_dpp v31, v31, v31 row_ror:8 row_mask:0xf bank_mask:0x3
    v_add_f32_dpp v24, v32, v32 row_ror:8 row_mask:0xf bank_mask:0xc
    v_add_f32_dpp v25, v33, v33 row_ror:8 row_mask:0xf bank_mask:0xc
    v_add_f32_dpp v26, v34, v34 row_ror:8 row_mask:0xf bank_mask:0xc
    v_add_f32_dpp v27, v35, v35 row_ror:8 row_mask:0xf bank_mask:0xc
    v_add_f32_dpp v28, v36, v36 row_ror:8 row_mask:0xf bank_mask:0xc
    v_add_f32_dpp v29, v37, v37 row_ror:8 row_mask:0xf bank_mask:0xc
    v_add_f32_dpp v30, v38, v38 row_ror:8 row_mask:0xf bank_mask:0xc
    v_add_f32_dpp v31, v39, v39 row_ror:8 row_mask:0xf bank_mask:0xc
    v_add_f32_dpp v24, v24, v24 row_shl:4 row_mask:0xf bank_mask:0x5
    v_add_f32_dpp v25, v25, v25 row_shl:4 row_mask:0xf bank_mask:0x5
    v_add_f32_dpp v26, v26, v26 row_shl:4 row_mask:0xf bank_mask:0x5
    v_add_f32_dpp v27, v27, v27 row_shl:4 row_mask:0xf bank_mask:0x5
    v_add_f32_dpp v24, v28, v28 row_shr:4 row_mask:0xf bank_mask:0xa
    v_add_f32_dpp v25, v29, v29 row_shr:4 row_mask:0xf bank_mask:0xa
    v_add_f32_dpp v26, v30, v30 row_shr:4 row_mask:0xf bank_mask:0xa
    v_add_f32_dpp v27, v31, v31 row_shr:4 row_mask:0xf bank_mask:0xa
    v_cvt_pk_bf16_f32 v24, v24, v25
    v_cvt_pk_bf16_f32 v25, v26, v27
    ds_write_b64 v56, v[24:25] offset:1312
    s_cmp_lt_u32 s16, 12
    s_cbranch_scc1 K_wait_end
K_epi:
    s_waitcnt vmcnt(0)
    v_and_b32 v10, 15, v0
    v_bfe_u32 v11, v0, 4, 2
    v_lshlrev_b32 v9, 8, v11
    v_lshl_add_u32 v9, v10, 3, v9
    ds_read_u16 v96, v9 offset:27936
    ds_read_u16 v97, v9 offset:28960
    ds_read_u16 v98, v9 offset:29984
    ds_read_u16 v99, v9 offset:31008
    ds_read_u16 v100, v9 offset:28064
    ds_read_u16 v101, v9 offset:29088
    ds_read_u16 v102, v9 offset:30112
    ds_read_u16 v103, v9 offset:31136
    ds_read_u16 v104, v9 offset:32032
    ds_read_u16 v105, v9 offset:33056
    ds_read_u16 v106, v9 offset:34080
    ds_read_u16 v107, v9 offset:35104
    ds_read_u16 v108, v9 offset:32160
    ds_read_u16 v109, v9 offset:33184
    ds_read_u16 v110, v9 offset:34208
    ds_read_u16 v111, v9 offset:35232
    ds_read_u16 v112, v9 offset:27938
    ds_read_u16 v113, v9 offset:28962
    ds_read_u16 v114, v9 offset:29986
    ds_read_u16 v115, v9 offset:31010
    ds_read_u16 v116, v9 offset:28066
    ds_read_u16 v117, v9 offset:29090
    ds_read_u16 v118, v9 offset:30114
    ds_read_u16 v119, v9 offset:31138
    ds_read_u16 v120, v9 offset:32034
    ds_read_u16 v121, v9 offset:33058
    ds_read_u16 v122, v9 offset:34082
    ds_read_u16 v123, v9 offset:35106
    ds_read_u16 v124, v9 offset:32162
    ds_read_u16 v125, v9 offset:33186
    ds_read_u16 v126, v9 offset:34210
    ds_read_u16 v127, v9 offset:35234
    s_waitcnt lgkmcnt(0)
    v_lshl_or_b32 v64, v97, 16, v96
    v_lshl_or_b32 v65, v99, 16, v98
    v_lshl_or_b32 v66, v101, 16, v100
    v_lshl_or_b32 v67, v103, 16, v102
    v_lshl_or_b32 v68, v105, 16, v104
    v_lshl_or_b32 v69, v107, 16, v106
    v_lshl_or_b32 v70, v109, 16, v108
    v_lshl_or_b32 v71, v111, 16, v110
    v_lshl_or_b32 v72, v113, 16, v112
    v_lshl_or_b32 v73, v115, 16, v114
    v_lshl_or_b32 v74, v117, 16, v116
    v_lshl_or_b32 v75, v119, 16, v118
    v_lshl_or_b32 v76, v121, 16, v120
    v_lshl_or_b32 v77, v123, 16, v122
    v_lshl_or_b32 v78, v125, 16, v124
    v_lshl_or_b32 v79, v127, 16, v126
    ds_read_u16 v96, v9 offset:27940
    ds_read_u16 v97, v9 offset:28964
    ds_read_u16 v98, v9 offset:29988
    ds_read_u16 v99, v9 offset:31012
    ds_read_u16 v100, v9 offset:28068
    ds_read_u16 v101, v9 offset:29092
    ds_read_u16 v102, v9 offset:30116
    ds_read_u16 v103, v9 offset:31140
    ds_read_u16 v104, v9 offset:32036
    ds_read_u16 v105, v9 offset:33060
    ds_read_u16 v106, v9 offset:34084
    ds_read_u16 v107, v9 offset:35108
    ds_read_u16 v108, v9 offset:32164
    ds_read_u16 v109, v9 offset:33188
    ds_read_u16 v110, v9 offset:34212
    ds_read_u16 v111, v9 offset:35236
    ds_read_u16 v112, v9 offset:27942
    ds_read_u16 v113, v9 offset:28966
    ds_read_u16 v114, v9 offset:29990
    ds_read_u16 v115, v9 offset:31014
    ds_read_u16 v116, v9 offset:28070
    ds_read_u16 v117, v9 offset:29094
    ds_read_u16 v118, v9 offset:30118
    ds_read_u16 v119, v9 offset:31142
    ds_read_u16 v120, v9 offset:32038
    ds_read_u16 v121, v9 offset:33062
    ds_read_u16 v122, v9 offset:34086
    ds_read_u16 v123, v9 offset:35110
    ds_read_u16 v124, v9 offset:32166
    ds_read_u16 v125, v9 offset:33190
    ds_read_u16 v126, v9 offset:34214
    ds_read_u16 v127, v9 offset:35238
    s_waitcnt lgkmcnt(0)
    v_lshl_or_b32 v80, v97, 16, v96
    v_lshl_or_b32 v81, v99, 16, v98
    v_lshl_or_b32 v82, v101, 16, v100
    v_lshl_or_b32 v83, v103, 16, v102
    v_lshl_or_b32 v84, v105, 16, v104
    v_lshl_or_b32 v85, v107, 16, v106
    v_lshl_or_b32 v86, v109, 16, v108
    v_lshl_or_b32 v87, v111, 16, v110
    v_lshl_or_b32 v88, v113, 16, v112
    v_lshl_or_b32 v89, v115, 16, v114
    v_lshl_or_b32 v90, v117, 16, v116
    v_lshl_or_b32 v91, v119, 16, v118
    v_lshl_or_b32 v92, v121, 16, v120
    v_lshl_or_b32 v93, v123, 16, v122
    v_lshl_or_b32 v94, v125, 16, v124
    v_lshl_or_b32 v95, v127, 16, v126
    v_bfe_u32 v12, v0, 6, 2
    v_lshl_add_u32 v13, v12, 4, v10
    v_mul_u32_u24 v13, 144, v13
    v_lshl_add_u32 v13, v11, 4, v13
    v_lshl_add_u32 v14, v12, 2, v11
    v_lshlrev_b32 v14, 17, v14
    v_lshl_add_u32 v14, v10, 3, v14
    s_lshl_b32 s19, s17, 7
    v_add_u32 v14, s19, v14
    v_add_u32 v15, 0x8000, v14
    v_add_u32 v16, 0x10000, v14
    v_add_u32 v17, 0x18000, v14
    s_mov_b32 s24, s50
    s_and_b32 s25, s51, 0xffff
    s_mov_b32 s26, 1600000
    s_mov_b32 s27, 0x20000
    s_waitcnt lgkmcnt(0)
    s_barrier
    ds_read_b128 v[40:43], v13 offset:1312
    ds_read_b128 v[44:47], v13 offset:1376
    s_waitcnt lgkmcnt(1)
    v_mfma_f32_16x16x32_bf16 v[96:99], v[40:43], v[64:67], 0
    v_mfma_f32_16x16x32_bf16 v[100:103], v[40:43], v[72:75], 0
    v_mfma_f32_16x16x32_bf16 v[104:107], v[40:43], v[80:83], 0
    v_mfma_f32_16x16x32_bf16 v[108:111], v[40:43], v[88:91], 0
    s_waitcnt lgkmcnt(0)
    v_mfma_f32_16x16x32_bf16 v[96:99], v[44:47], v[68:71], v[96:99]
    v_mfma_f32_16x16x32_bf16 v[100:103], v[44:47], v[76:79], v[100:103]
    v_mfma_f32_16x16x32_bf16 v[104:107], v[44:47], v[84:87], v[104:107]
    v_mfma_f32_16x16x32_bf16 v[108:111], v[44:47], v[92:95], v[108:111]
    s_nop 7
    s_cmp_lg_u32 s16, 15
    s_cbranch_scc1 K_nosum
    v_add_f32 v96, v96, v97
    v_add_f32 v98, v98, v99
    v_add_f32 v100, v100, v101
    v_add_f32 v102, v102, v103
    v_add_f32 v104, v104, v105
    v_add_f32 v106, v106, v107
    v_add_f32 v108, v108, v109
    v_add_f32 v110, v110, v111
    v_add_f32 v96, v96, v98
    v_add_f32 v100, v100, v102
    v_add_f32 v104, v104, v106
    v_add_f32 v108, v108, v110
K_nosum:
    v_cvt_pk_bf16_f32 v24, v96, v100
    v_cvt_pk_bf16_f32 v25, v104, v108
    buffer_store_dwordx2 v[24:25], v14, s[24:27], 0 offen sc1
    v_cvt_pk_bf16_f32 v26, v97, v101
    v_cvt_pk_bf16_f32 v27, v105, v109
    buffer_store_dwordx2 v[26:27], v15, s[24:27], 0 offen sc1
    v_cvt_pk_bf16_f32 v28, v98, v102
    v_cvt_pk_bf16_f32 v29, v106, v110
    buffer_store_dwordx2 v[28:29], v16, s[24:27], 0 offen sc1
    v_cvt_pk_bf16_f32 v30, v99, v103
    v_cvt_pk_bf16_f32 v31, v107, v111
    buffer_store_dwordx2 v[30:31], v17, s[24:27], 0 offen sc1
    s_endpgm
K_wait_end:
    s_waitcnt lgkmcnt(0)
    s_barrier
K_end:
    s_endpgm
K_t0:
    s_waitcnt vmcnt(2)
    s_branch K_go0
K_t1:
    s_waitcnt vmcnt(4)
    s_branch K_go0
K_t2:
    s_waitcnt vmcnt(6)
    s_branch K_go0
K_ovf:
    v_lshlrev_b32 v60, 4, v0
    v_add_u32 v60, 62000, v60
    ds_write_b128 v60, v[40:43]
    ds_write_b128 v60, v[44:47] offset:16384
    ds_write_b128 v60, v[8:11] offset:32768
    ds_write_b128 v60, v[12:15] offset:49152
    s_mov_b32 s42, 0
    s_mov_b32 s35, 0
K_mx:
    v_readlane_b32 s36, v56, s35
    s_max_u32 s42, s42, s36
    s_add_u32 s35, s35, 1
    s_cmp_lt_u32 s35, 49
    s_cbranch_scc1 K_mx
    s_mov_b32 s37, 0
K_npass:
    s_waitcnt vmcnt(0) lgkmcnt(0)
    s_barrier
    v_lshlrev_b32 v56, 4, v0
    v_mov_b32 v44, 0x7fffff80
    v_mov_b32 v45, 0x7fffff80
    v_mov_b32 v46, 0x7fffff80
    v_mov_b32 v47, 0x7fffff80
    ds_write_b128 v56, v[44:47] offset:36128
    v_cmp_gt_u32 vcc, 9488, v56
    s_and_saveexec_b64 s[20:21], vcc
    ds_write_b128 v56, v[44:47] offset:52512
    s_mov_b64 exec, s[20:21]
    s_waitcnt lgkmcnt(0)
    s_barrier
    v_add_u32 v60, 62000, v56
    ds_read_b128 v[40:43], v60
    ds_read_b128 v[44:47], v60 offset:16384
    ds_read_b128 v[8:11], v60 offset:32768
    ds_read_b128 v[12:15], v60 offset:49152
    s_movk_i32 s35, 128
    s_movk_i32 s36, 264
    s_movk_i32 s39, 126
    s_waitcnt lgkmcnt(0)
    v_subrev_u32 v8, s37, v8
    v_and_b32 v49, 127, v40
    v_mul_u32_u24 v48, s36, v49
    v_lshl_add_u32 v48, v8, 2, v48
    v_cmpx_ne_u32 vcc, s39, v49
    v_cmpx_gt_u32 vcc, s35, v8
    ds_write_b32 v48, v40 offset:36128
    s_mov_b64 exec, -1
    v_subrev_u32 v9, s37, v9
    v_and_b32 v49, 127, v41
    v_mul_u32_u24 v48, s36, v49
    v_lshl_add_u32 v48, v9, 2, v48
    v_cmpx_ne_u32 vcc, s39, v49
    v_cmpx_gt_u32 vcc, s35, v9
    ds_write_b32 v48, v41 offset:36128
    s_mov_b64 exec, -1
    v_subrev_u32 v10, s37, v10
    v_and_b32 v49, 127, v42
    v_mul_u32_u24 v48, s36, v49
    v_lshl_add_u32 v48, v10, 2, v48
    v_cmpx_ne_u32 vcc, s39, v49
    v_cmpx_gt_u32 vcc, s35, v10
    ds_write_b32 v48, v42 offset:36128
    s_mov_b64 exec, -1
    v_subrev_u32 v11, s37, v11
    v_and_b32 v49, 127, v43
    v_mul_u32_u24 v48, s36, v49
    v_lshl_add_u32 v48, v11, 2, v48
    v_cmpx_ne_u32 vcc, s39, v49
    v_cmpx_gt_u32 vcc, s35, v11
    ds_write_b32 v48, v43 offset:36128
    s_mov_b64 exec, -1
    v_subrev_u32 v12, s37, v12
    v_and_b32 v49, 127, v44
    v_mul_u32_u24 v48, s36, v49
    v_lshl_add_u32 v48, v12, 2, v48
    v_cmpx_ne_u32 vcc, s39, v49
    v_cmpx_gt_u32 vcc, s35, v12
    ds_write_b32 v48, v44 offset:36128
    s_mov_b64 exec, -1
    v_subrev_u32 v13, s37, v13
    v_and_b32 v49, 127, v45
    v_mul_u32_u24 v48, s36, v49
    v_lshl_add_u32 v48, v13, 2, v48
    v_cmpx_ne_u32 vcc, s39, v49
    v_cmpx_gt_u32 vcc, s35, v13
    ds_write_b32 v48, v45 offset:36128
    s_mov_b64 exec, -1
    v_subrev_u32 v14, s37, v14
    v_and_b32 v49, 127, v46
    v_mul_u32_u24 v48, s36, v49
    v_lshl_add_u32 v48, v14, 2, v48
    v_cmpx_ne_u32 vcc, s39, v49
    v_cmpx_gt_u32 vcc, s35, v14
    ds_write_b32 v48, v46 offset:36128
    s_mov_b64 exec, -1
    v_subrev_u32 v15, s37, v15
    v_and_b32 v49, 127, v47
    v_mul_u32_u24 v48, s36, v49
    v_lshl_add_u32 v48, v15, 2, v48
    v_cmpx_ne_u32 vcc, s39, v49
    v_cmpx_gt_u32 vcc, s35, v15
    ds_write_b32 v48, v47 offset:36128
    s_mov_b64 exec, -1
    v_mov_b32 v96, 0
    v_mov_b32 v97, 0
    v_mov_b32 v98, 0
    v_mov_b32 v99, 0
    v_mov_b32 v100, 0
    v_mov_b32 v101, 0
    v_mov_b32 v102, 0
    v_mov_b32 v103, 0
    v_mov_b32 v104, 0
    v_mov_b32 v105, 0
    v_mov_b32 v106, 0
    v_mov_b32 v107, 0
    v_mov_b32 v108, 0
    v_mov_b32 v109, 0
    v_mov_b32 v110, 0
    v_mov_b32 v111, 0
    v_mov_b32 v112, 0
    v_mov_b32 v113, 0
    v_mov_b32 v114, 0
    v_mov_b32 v115, 0
    v_mov_b32 v116, 0
    v_mov_b32 v117, 0
    v_mov_b32 v118, 0
    v_mov_b32 v119, 0
    v_mov_b32 v120, 0
    v_mov_b32 v121, 0
    v_mov_b32 v122, 0
    v_mov_b32 v123, 0
    v_mov_b32 v124, 0
    v_mov_b32 v125, 0
    v_mov_b32 v126, 0
    v_mov_b32 v127, 0
    v_min_u32 v59, 48, v7
    v_lshlrev_b32 v59, 2, v59
    s_waitcnt lgkmcnt(0)
    s_barrier
    ds_read2_b32 v[48:49], v5 offset0:0 offset1:4
    ds_read2_b32 v[50:51], v5 offset0:8 offset1:12
    ds_read_b32 v59, v59 offset:1024
    s_add_u32 s35, s37, 128
    s_cmp_lt_u32 s35, s42
    s_cselect_b32 s38, 1, 0
    s_waitcnt lgkmcnt(0)
    s_cmp_gt_u32 s16, 12
    s_cbranch_scc1 K_rdone
    v_add_u32 v48, v48, v6
    buffer_load_dwordx4 v[64:67], v48, s[12:15], 0 offen
    buffer_load_dwordx4 v[68:71], v48, s[12:15], 0 offen offset:64
    v_add_u32 v49, v49, v6
    buffer_load_dwordx4 v[72:75], v49, s[12:15], 0 offen
    buffer_load_dwordx4 v[76:79], v49, s[12:15], 0 offen offset:64
    v_add_u32 v50, v50, v6
    buffer_load_dwordx4 v[80:83], v50, s[12:15], 0 offen
    buffer_load_dwordx4 v[84:87], v50, s[12:15], 0 offen offset:64
    v_add_u32 v51, v51, v6
    buffer_load_dwordx4 v[88:91], v51, s[12:15], 0 offen
    buffer_load_dwordx4 v[92:95], v51, s[12:15], 0 offen offset:64
    s_branch K_pass
K_more:
    s_cmp_eq_u32 s38, 0
    s_cbranch_scc1 K_next
    s_add_u32 s37, s37, 128
    s_branch K_npass
K_next:
    s_waitcnt lgkmcnt(0)
    s_barrier
    v_lshlrev_b32 v56, 4, v0
    v_mov_b32 v40, 0
    v_mov_b32 v44, 0x7fffff80
    v_mov_b32 v41, 0
    v_mov_b32 v45, 0x7fffff80
    v_mov_b32 v42, 0
    v_mov_b32 v46, 0x7fffff80
    v_mov_b32 v43, 0
    v_mov_b32 v47, 0x7fffff80
    v_cmp_gt_u32 vcc, 256, v56
    s_and_saveexec_b64 s[20:21], vcc
    ds_write_b128 v56, v[40:43] offset:1024
    s_mov_b64 exec, s[20:21]
    ds_write_b128 v56, v[44:47] offset:36128
    v_cmp_gt_u32 vcc, 9488, v56
    s_and_saveexec_b64 s[20:21], vcc
    ds_write_b128 v56, v[44:47] offset:52512
    s_mov_b64 exec, s[20:21]
    v_mov_b32 v96, 0
    v_mov_b32 v97, 0
    v_mov_b32 v98, 0
    v_mov_b32 v99, 0
    v_mov_b32 v100, 0
    v_mov_b32 v101, 0
    v_mov_b32 v102, 0
    v_mov_b32 v103, 0
    v_mov_b32 v104, 0
    v_mov_b32 v105, 0
    v_mov_b32 v106, 0
    v_mov_b32 v107, 0
    v_mov_b32 v108, 0
    v_mov_b32 v109, 0
    v_mov_b32 v110, 0
    v_mov_b32 v111, 0
    v_mov_b32 v112, 0
    v_mov_b32 v113, 0
    v_mov_b32 v114, 0
    v_mov_b32 v115, 0
    v_mov_b32 v116, 0
    v_mov_b32 v117, 0
    v_mov_b32 v118, 0
    v_mov_b32 v119, 0
    v_mov_b32 v120, 0
    v_mov_b32 v121, 0
    v_mov_b32 v122, 0
    v_mov_b32 v123, 0
    v_mov_b32 v124, 0
    v_mov_b32 v125, 0
    v_mov_b32 v126, 0
    v_mov_b32 v127, 0
    v_and_b32 v52, 3, v0
    s_add_u32 s33, s33, 8
    s_mov_b32 s37, 0
    s_waitcnt lgkmcnt(0)
    s_barrier
    s_branch K_batch
.section .rodata,"a"
.p2align 6
.amdhsa_kernel gather_scatter__kernel_systems_refs_featgraph__graph_kernel
  .amdhsa_next_free_vgpr 128
  .amdhsa_next_free_sgpr 100
  .amdhsa_accum_offset 128
  .amdhsa_group_segment_fixed_size 0
  .amdhsa_kernarg_size 64
  .amdhsa_user_sgpr_count 2
  .amdhsa_user_sgpr_kernarg_segment_ptr 1
  .amdhsa_system_sgpr_workgroup_id_x 1
.end_amdhsa_kernel
.text
```
